```python
import torch

def _softmax(x, axis=-1):
    return torch.softmax(x, dim=axis)
def _gelu(x):
    return torch.nn.functional.gelu(x, approximate="tanh")
def _silu(x):
    return torch.nn.functional.silu(x)
def _sigmoid(x):
    return torch.sigmoid(x)
def _layernorm(x, axis=-1, eps=1e-5):
    m = x.mean(dim=axis, keepdim=True)
    v = x.var(dim=axis, keepdim=True, unbiased=False)
    return (x - m) / torch.sqrt(v + eps)
def _scatter_add(tgt, idx, src, axis=0):
    return tgt.clone().index_add_(axis, idx, src)
def _segment_sum(src, seg, n):
    out = torch.zeros((n,) + src.shape[1:], dtype=src.dtype)
    return out.index_add_(0, seg, src)
def _pad(x, pw):
    flat = tuple(v for pair in reversed(pw) for v in pair)
    return torch.nn.functional.pad(x, flat)

kernel_name = 'standalone__mha_block_cached__near_ridge'

def setup_inputs():

    _w = (lambda a: (lambda t: t.to(torch.bfloat16) if t.is_floating_point() else t)(torch.as_tensor(a)))
    B, Sq, D = 16, 48, 1024
    H, Sk, Dh = 32, 48, 128
    return {
        "x": _w((lambda *s: torch.randn(*s, dtype=torch.bfloat16) * 0.8)(B, Sq, D)),
        "k_cache": _w((lambda *s: torch.randn(*s, dtype=torch.bfloat16) * 0.8)(B, H, Sk, Dh)),
        "v_cache": _w((lambda *s: torch.randn(*s, dtype=torch.bfloat16) * 0.05)(B, H, Sk, Dh)),
        "wq": _w((lambda *s: torch.randn(*s, dtype=torch.bfloat16) * 0.8)(D, H * Dh) * (D ** -0.5)),
        "wo": _w((lambda *s: torch.randn(*s, dtype=torch.bfloat16) * 0.05)(H * Dh, D) * ((H * Dh) ** -0.5)),
    }

def reference(x, k_cache, v_cache, wq, wo):
    B, Sq, D = x.shape
    H, Dh = 32, 128
    q = (lambda x, *d: x.permute(*d))((x @ wq).reshape(B, Sq, H, Dh), 0, 2, 1, 3)
    scores = torch.einsum("bhqd,bhkd->bhqk", q, k_cache) * (Dh ** -0.5)
    p = _softmax(scores, axis=-1)
    o = torch.einsum("bhqk,bhkd->bhqd", p, v_cache)
    return (lambda x, *d: x.permute(*d))(o, 0, 2, 1, 3).reshape(B, Sq, H * Dh) @ wo
```

```asm
; @launch grid=(256,1,1) block=(256,1,1) lds=163840
.amdgcn_target "amdgcn-amd-amdhsa--gfx950"
.text
.globl standalone__mha_block_cached__near_ridge_kernel
.p2align 8
.type standalone__mha_block_cached__near_ridge_kernel,@function
standalone__mha_block_cached__near_ridge_kernel:
    s_cmp_ge_u32 s2, 256
    s_cbranch_scc1 L_done
    s_load_dwordx16 s[64:79], s[0:1], 0
    v_and_b32 v1, 63, v0
    v_lshrrev_b32 v2, 6, v0
    s_and_b32 s55, s2, 7
    v_readfirstlane_b32 s44, v2
    s_lshr_b32 s56, s2, 3
    s_and_b32 s41, s55, 3
    s_and_b32 s42, s56, 7
    s_lshr_b32 s57, s55, 2
    s_lshl_b32 s57, s57, 2
    s_lshr_b32 s58, s56, 3
    s_add_u32 s40, s57, s58
    s_lshl_b32 s57, s41, 3
    s_add_u32 s43, s57, s42
    s_and_b32 s45, s44, 1
    s_lshr_b32 s46, s44, 1
    s_lshl_b32 s47, s44, 12
    s_mul_i32 s48, s44, 3072
    s_add_u32 s48, s48, 16384
    s_lshr_b32 s57, s55, 2
    s_lshl_b32 s57, s57, 1
    s_add_u32 s57, s57, s41
    s_and_b32 s57, s57, 3
    s_lshl_b32 s51, s57, 2
    s_add_u32 s57, s40, s42
    s_and_b32 s57, s57, 1
    s_lshl_b32 s57, s57, 1
    s_add_u32 s51, s51, s57
    v_lshrrev_b32 v2, 4, v1
    v_and_b32 v3, 15, v1
    v_lshlrev_b32 v4, 1, v2
    v_xor_b32 v4, v4, v3
    v_lshlrev_b32 v4, 4, v4
    v_lshlrev_b32 v5, 13, v2
    v_add_u32 v4, v4, v5
    s_lshl_b32 s57, s44, 17
    s_lshl_b32 s58, s43, 8
    s_add_u32 s57, s57, s58
    v_add_u32 v4, s57, v4
    v_add_u32 v10, 0, v4
    v_add_u32 v11, 31744, v4
    v_xor_b32 v12, 128, v4
    v_add_u32 v12, 63488, v12
    v_xor_b32 v13, 128, v4
    v_add_u32 v13, 95232, v13
    v_lshrrev_b32 v5, 3, v1
    s_mul_i32 s57, s44, 24
    s_mul_i32 s58, s40, 96
    v_and_b32 v8, 7, v1
    s_add_u32 s59, s57, 0
    v_add_u32 v6, s59, v5
    v_lshrrev_b32 v7, 1, v6
    v_and_b32 v7, 7, v7
    v_xor_b32 v7, v7, v8
    v_lshlrev_b32 v7, 4, v7
    v_add_u32 v6, s58, v6
    v_lshlrev_b32 v6, 11, v6
    v_add_u32 v14, v6, v7
    s_add_u32 s59, s57, 8
    v_add_u32 v6, s59, v5
    v_lshrrev_b32 v7, 1, v6
    v_and_b32 v7, 7, v7
    v_xor_b32 v7, v7, v8
    v_lshlrev_b32 v7, 4, v7
    v_add_u32 v6, s58, v6
    v_lshlrev_b32 v6, 11, v6
    v_subrev_u32 v6, 1024, v6
    v_add_u32 v15, v6, v7
    s_add_u32 s59, s57, 16
    v_add_u32 v6, s59, v5
    v_lshrrev_b32 v7, 1, v6
    v_and_b32 v7, 7, v7
    v_xor_b32 v7, v7, v8
    v_lshlrev_b32 v7, 4, v7
    v_add_u32 v6, s58, v6
    v_lshlrev_b32 v6, 11, v6
    v_subrev_u32 v6, 2048, v6
    v_add_u32 v16, v6, v7
    v_and_b32 v2, 15, v1
    v_lshrrev_b32 v3, 4, v1
    v_bfe_u32 v4, v1, 2, 2
    v_and_b32 v5, 3, v1
    v_lshlrev_b32 v53, 4, v1
    v_lshl_add_u32 v6, v3, 3, v4
    v_lshlrev_b32 v6, 8, v6
    v_and_b32 v7, 1, v5
    v_lshl_add_u32 v6, v7, 3, v6
    v_and_b32 v7, 1, v3
    v_lshlrev_b32 v7, 3, v7
    v_lshl_add_u32 v7, v4, 1, v7
    v_lshrrev_b32 v8, 1, v5
    s_lshl_b32 s55, s46, 3
    v_add_u32 v8, s55, v8
    v_xor_b32 v7, v7, v8
    v_xor_b32 v8, 0, v7
    v_lshl_add_u32 v29, v8, 4, v6
    v_add_u32 v33, 57344, v29
    v_xor_b32 v8, 2, v7
    v_lshl_add_u32 v30, v8, 4, v6
    v_add_u32 v34, 57344, v30
    v_xor_b32 v8, 4, v7
    v_lshl_add_u32 v31, v8, 4, v6
    v_add_u32 v35, 57344, v31
    v_xor_b32 v8, 6, v7
    v_lshl_add_u32 v32, v8, 4, v6
    v_add_u32 v36, 57344, v32
    s_mul_i32 s55, s45, 48
    v_add_u32 v6, s55, v2
    v_lshlrev_b32 v6, 7, v6
    v_add_u32 v6, 16384, v6
    v_lshrrev_b32 v7, 1, v2
    v_xor_b32 v7, v7, v3
    v_lshl_add_u32 v37, v7, 4, v6
    v_xor_b32 v38, 64, v37
    v_add_u32 v39, 57344, v37
    v_add_u32 v40, 57344, v38
    s_waitcnt lgkmcnt(0)
    s_mov_b32 s12, s70
    s_mov_b32 s13, s71
    s_mov_b32 s14, 8388608
    s_mov_b32 s15, 0x20000
    s_mov_b32 s8, s64
    s_mov_b32 s9, s65
    s_mov_b32 s10, 1572864
    s_mov_b32 s11, 0x20000
    s_add_u32 s50, s51, 0
    s_and_b32 s50, s50, 15
    s_lshl_b32 s49, s50, 19
    s_lshl_b32 s50, s50, 7
    s_add_u32 m0, s47, 0
    s_nop 0
    buffer_load_dwordx4 v10, s[12:15], s49 offen offset:0  lds
    buffer_load_dwordx4 v11, s[12:15], s49 offen offset:1024  lds
    buffer_load_dwordx4 v12, s[12:15], s49 offen offset:2048  lds
    buffer_load_dwordx4 v13, s[12:15], s49 offen offset:3072  lds
    s_add_u32 m0, s48, 0
    s_nop 0
    buffer_load_dwordx4 v14, s[8:11], s50 offen offset:0  lds
    buffer_load_dwordx4 v15, s[8:11], s50 offen offset:1024  lds
    buffer_load_dwordx4 v16, s[8:11], s50 offen offset:2048  lds
    s_add_u32 s50, s51, 1
    s_and_b32 s50, s50, 15
    s_lshl_b32 s49, s50, 19
    s_lshl_b32 s50, s50, 7
    s_add_u32 m0, s47, 28672
    s_nop 0
    buffer_load_dwordx4 v10, s[12:15], s49 offen offset:0  lds
    buffer_load_dwordx4 v11, s[12:15], s49 offen offset:1024  lds
    buffer_load_dwordx4 v12, s[12:15], s49 offen offset:2048  lds
    buffer_load_dwordx4 v13, s[12:15], s49 offen offset:3072  lds
    s_add_u32 m0, s48, 28672
    s_nop 0
    buffer_load_dwordx4 v14, s[8:11], s50 offen offset:0  lds
    buffer_load_dwordx4 v15, s[8:11], s50 offen offset:1024  lds
    buffer_load_dwordx4 v16, s[8:11], s50 offen offset:2048  lds
    s_mov_b32 s16, s66
    s_mov_b32 s17, s67
    s_mov_b32 s18, 6291456
    s_mov_b32 s19, 0x20000
    s_mov_b32 s20, s68
    s_mov_b32 s21, s69
    s_mov_b32 s22, 6291456
    s_mov_b32 s23, 0x20000
    s_mov_b32 s24, s78
    s_mov_b32 s25, s79
    s_mov_b32 s26, 268435456
    s_mov_b32 s27, 0x20000
    s_mov_b32 s28, s72
    s_mov_b32 s29, s73
    s_mov_b32 s30, 8388608
    s_mov_b32 s31, 0x20000
    s_mov_b32 s32, s74
    s_mov_b32 s33, s75
    s_mov_b32 s34, 1572864
    s_mov_b32 s35, 0x20000
    s_mov_b32 s36, s76
    s_mov_b32 s37, s77
    s_mov_b32 s38, 256
    s_mov_b32 s39, 0x20000
    s_lshl_b32 s55, s40, 2
    s_add_u32 s55, s55, s41
    s_lshl_b32 s55, s55, 10
    s_add_u32 s57, s55, 20971520
    s_lshl_b32 s56, s42, 2
    s_add_u32 s56, s56, s44
    s_lshl_b32 s56, s56, 2
    s_add_u32 s55, s55, s56
    s_add_u32 s55, s55, 20971520
    v_mov_b32 v59, s55
    v_mov_b32 v7, 0
    s_lshl_b32 s55, s40, 3
    s_add_u32 s55, s55, s42
    s_lshl_b32 s55, s55, 2
    s_add_u32 s55, s55, s41
    s_lshl_b32 s55, s55, 10
    s_add_u32 s55, s55, 21037056
    s_and_b32 s56, s44, 1
    s_lshl_b32 s56, s56, 7
    s_add_u32 s55, s55, s56
    s_lshr_b32 s56, s44, 1
    s_lshl_b32 s56, s56, 9
    s_add_u32 s55, s55, s56
    v_and_b32 v8, 3, v1
    v_lshlrev_b32 v8, 2, v8
    v_add_u32 v58, s55, v8
    s_sub_u32 s56, s57, 0
    v_and_b32 v9, 31, v1
    v_lshlrev_b32 v9, 2, v9
    v_add_u32 v9, s56, v9
    s_or_b32 s56, s42, s44
    s_cmp_eq_u32 s56, 0
    s_cselect_b64 exec, -1, 0
    buffer_store_dword v7, v9, s[24:27], 0 offen sc1
    s_mov_b64 exec, -1
    v_and_b32 v8, 31, v1
    v_lshlrev_b32 v8, 2, v8
    v_add_u32 v8, s55, v8
    buffer_store_dword v7, v8, s[24:27], 0 offen sc1
    s_lshl_b32 s55, s40, 3
    s_add_u32 s55, s55, s42
    s_lshl_b32 s55, s55, 2
    s_add_u32 s55, s55, s41
    s_mul_i32 s55, s55, 49152
    s_add_u32 s55, s55, 6291456
    s_lshl_b32 s57, s44, 11
    s_and_b32 s58, s44, 1
    s_lshl_b32 s58, s58, 11
    s_add_u32 s58, s58, 8192
    s_add_u32 s56, s41, 1
    s_and_b32 s56, s56, 3
    s_mul_i32 s56, s56, 12288
    s_add_u32 s56, s56, s55
    s_add_u32 s79, s56, s57
    s_add_u32 s82, s56, s58
    s_add_u32 s56, s41, 2
    s_and_b32 s56, s56, 3
    s_mul_i32 s56, s56, 12288
    s_add_u32 s56, s56, s55
    s_add_u32 s80, s56, s57
    s_add_u32 s83, s56, s58
    s_add_u32 s56, s41, 3
    s_and_b32 s56, s56, 3
    s_mul_i32 s56, s56, 12288
    s_add_u32 s56, s56, s55
    s_add_u32 s81, s56, s57
    s_add_u32 s89, s56, s58
    s_lshr_b32 s57, s44, 1
    s_and_b32 s58, s41, 1
    s_cmp_eq_u32 s57, s58
    s_cselect_b32 s84, 1, 0
    s_cselect_b64 s[6:7], -1, 0
    v_mov_b32 v220, -1
    v_mov_b32 v221, -1
    v_mov_b32 v222, -1
    v_mov_b32 v223, -1
    s_mov_b64 exec, s[6:7]
    buffer_store_dwordx4 v[220:223], v53, s[24:27], s82 offen offset:0 sc1
    s_mov_b64 exec, -1
    s_mov_b64 exec, s[6:7]
    buffer_store_dwordx4 v[220:223], v53, s[24:27], s83 offen offset:0 sc1
    s_mov_b64 exec, -1
    s_mov_b64 exec, s[6:7]
    buffer_store_dwordx4 v[220:223], v53, s[24:27], s89 offen offset:0 sc1
    s_mov_b64 exec, -1
    s_waitcnt vmcnt(12)
    s_barrier
    ds_read_b128 v[100:103], v37 offset:0
    ds_read_b128 v[104:107], v37 offset:2048
    ds_read_b128 v[108:111], v37 offset:4096
    ds_read_b64_tr_b16 v[68:69], v29 offset:0
    ds_read_b64_tr_b16 v[70:71], v29 offset:1024
    ds_read_b64_tr_b16 v[72:73], v30 offset:0
    ds_read_b64_tr_b16 v[74:75], v30 offset:1024
    ds_read_b64_tr_b16 v[76:77], v31 offset:0
    ds_read_b64_tr_b16 v[78:79], v31 offset:1024
    ds_read_b64_tr_b16 v[80:81], v32 offset:0
    ds_read_b64_tr_b16 v[82:83], v32 offset:1024
    s_waitcnt lgkmcnt(0)
    ds_read_b128 v[112:115], v38 offset:0
    ds_read_b128 v[116:119], v38 offset:2048
    s_add_u32 s50, s51, 2
    s_and_b32 s50, s50, 15
    s_lshl_b32 s49, s50, 19
    s_lshl_b32 s50, s50, 7
    s_add_u32 m0, s47, 57344
    s_nop 0
    buffer_load_dwordx4 v10, s[12:15], s49 offen offset:0  lds
    buffer_load_dwordx4 v11, s[12:15], s49 offen offset:1024  lds
    buffer_load_dwordx4 v12, s[12:15], s49 offen offset:2048  lds
    v_mfma_f32_16x16x32_bf16 v[124:127], v[68:71], v[100:103], 0
    buffer_load_dwordx4 v13, s[12:15], s49 offen offset:3072  lds
    ds_read_b128 v[120:123], v38 offset:4096
    ds_read_b64_tr_b16 v[84:85], v29 offset:8192
    s_add_u32 m0, s48, 57344
    s_nop 0
    buffer_load_dwordx4 v14, s[8:11], s50 offen offset:0  lds
    buffer_load_dwordx4 v15, s[8:11], s50 offen offset:1024  lds
    s_mul_i32 s85, s44, 6144
    v_mfma_f32_16x16x32_bf16 v[128:131], v[68:71], v[104:107], 0
    buffer_load_dwordx4 v16, s[8:11], s50 offen offset:2048  lds
    ds_read_b64_tr_b16 v[86:87], v29 offset:9216
    ds_read_b64_tr_b16 v[88:89], v30 offset:8192
    s_lshl_b32 s53, s44, 10
    s_mov_b32 s52, 0x3e0293ee
    s_lshl_b32 s55, s40, 6
    s_add_u32 s55, s55, s43
    v_mfma_f32_16x16x32_bf16 v[132:135], v[68:71], v[108:111], 0
    ds_read_b64_tr_b16 v[90:91], v30 offset:9216
    s_mul_i32 s55, s55, 12288
    s_lshr_b32 s56, s44, 1
    s_mul_i32 s56, s56, 393216
    s_add_u32 s55, s55, s56
    v_mfma_f32_16x16x32_bf16 v[136:139], v[72:75], v[100:103], 0
    ds_read_b64_tr_b16 v[92:93], v31 offset:8192
    s_and_b32 s56, s44, 1
    s_mul_i32 s56, s56, 24
    s_add_u32 s57, s56, 0
    v_add_u32 v6, s57, v3
    v_mfma_f32_16x16x32_bf16 v[140:143], v[72:75], v[104:107], 0
    ds_read_b64_tr_b16 v[94:95], v31 offset:9216
    v_lshlrev_b32 v7, 8, v6
    v_add_u32 v7, s55, v7
    v_and_b32 v8, 15, v6
    v_xor_b32 v8, v8, v2
    v_mfma_f32_16x16x32_bf16 v[144:147], v[72:75], v[108:111], 0
    ds_read_b64_tr_b16 v[96:97], v32 offset:8192
    v_lshl_add_u32 v17, v8, 4, v7
    v_and_b32 v8, 7, v6
    v_lshlrev_b32 v8, 1, v8
    v_xor_b32 v8, v8, v2
    v_mfma_f32_16x16x32_bf16 v[148:151], v[76:79], v[100:103], 0
    ds_read_b64_tr_b16 v[98:99], v32 offset:9216
    v_lshl_add_u32 v23, v8, 4, v7
    s_add_u32 s57, s56, 4
    v_add_u32 v6, s57, v3
    v_lshlrev_b32 v7, 8, v6
    v_mfma_f32_16x16x32_bf16 v[152:155], v[76:79], v[104:107], 0
    v_add_u32 v7, s55, v7
    v_subrev_u32 v7, 1024, v7
    v_and_b32 v8, 15, v6
    v_xor_b32 v8, v8, v2
    v_mfma_f32_16x16x32_bf16 v[156:159], v[76:79], v[108:111], 0
    v_lshl_add_u32 v18, v8, 4, v7
    v_and_b32 v8, 7, v6
    v_lshlrev_b32 v8, 1, v8
    v_xor_b32 v8, v8, v2
    v_mfma_f32_16x16x32_bf16 v[160:163], v[80:83], v[100:103], 0
    v_lshl_add_u32 v24, v8, 4, v7
    s_add_u32 s57, s56, 8
    v_add_u32 v6, s57, v3
    v_lshlrev_b32 v7, 8, v6
    v_mfma_f32_16x16x32_bf16 v[164:167], v[80:83], v[104:107], 0
    v_add_u32 v7, s55, v7
    v_subrev_u32 v7, 2048, v7
    v_and_b32 v8, 15, v6
    v_xor_b32 v8, v8, v2
    v_mfma_f32_16x16x32_bf16 v[168:171], v[80:83], v[108:111], 0
    s_waitcnt vmcnt(12) lgkmcnt(0)
    s_barrier
    ds_read_b128 v[100:103], v37 offset:28672
    ds_read_b128 v[104:107], v37 offset:30720
    s_add_u32 s50, s51, 3
    s_and_b32 s50, s50, 15
    s_lshl_b32 s49, s50, 19
    s_lshl_b32 s50, s50, 7
    s_add_u32 m0, s47, 86016
    s_nop 0
    buffer_load_dwordx4 v10, s[12:15], s49 offen offset:0  lds
    buffer_load_dwordx4 v11, s[12:15], s49 offen offset:1024  lds
    buffer_load_dwordx4 v12, s[12:15], s49 offen offset:2048  lds
    v_mfma_f32_16x16x32_bf16 v[124:127], v[84:87], v[112:115], v[124:127]
    buffer_load_dwordx4 v13, s[12:15], s49 offen offset:3072  lds
    ds_read_b128 v[108:111], v37 offset:32768
    ds_read_b64_tr_b16 v[68:69], v29 offset:28672
    s_add_u32 m0, s48, 86016
    s_nop 0
    buffer_load_dwordx4 v14, s[8:11], s50 offen offset:0  lds
    buffer_load_dwordx4 v15, s[8:11], s50 offen offset:1024  lds
    v_lshl_add_u32 v19, v8, 4, v7
    v_mfma_f32_16x16x32_bf16 v[128:131], v[84:87], v[116:119], v[128:131]
    buffer_load_dwordx4 v16, s[8:11], s50 offen offset:2048  lds
    ds_read_b64_tr_b16 v[70:71], v29 offset:29696
    ds_read_b64_tr_b16 v[72:73], v30 offset:28672
    v_and_b32 v8, 7, v6
    v_lshlrev_b32 v8, 1, v8
    v_xor_b32 v8, v8, v2
    v_lshl_add_u32 v25, v8, 4, v7
    v_mfma_f32_16x16x32_bf16 v[132:135], v[84:87], v[120:123], v[132:135]
    ds_read_b64_tr_b16 v[74:75], v30 offset:29696
    s_add_u32 s57, s56, 12
    v_add_u32 v6, s57, v3
    v_lshlrev_b32 v7, 8, v6
    v_add_u32 v7, s55, v7
    v_mfma_f32_16x16x32_bf16 v[136:139], v[88:91], v[112:115], v[136:139]
    ds_read_b64_tr_b16 v[76:77], v31 offset:28672
    v_subrev_u32 v7, 3072, v7
    v_and_b32 v8, 15, v6
    v_xor_b32 v8, v8, v2
    v_lshl_add_u32 v20, v8, 4, v7
    v_mfma_f32_16x16x32_bf16 v[140:143], v[88:91], v[116:119], v[140:143]
    ds_read_b64_tr_b16 v[78:79], v31 offset:29696
    v_and_b32 v8, 7, v6
    v_lshlrev_b32 v8, 1, v8
    v_xor_b32 v8, v8, v2
    v_lshl_add_u32 v26, v8, 4, v7
    v_mfma_f32_16x16x32_bf16 v[144:147], v[88:91], v[120:123], v[144:147]
    ds_read_b64_tr_b16 v[80:81], v32 offset:28672
    s_add_u32 s57, s56, 16
    v_add_u32 v6, s57, v3
    v_lshlrev_b32 v7, 8, v6
    v_add_u32 v7, s55, v7
    v_mfma_f32_16x16x32_bf16 v[148:151], v[92:95], v[112:115], v[148:151]
    ds_read_b64_tr_b16 v[82:83], v32 offset:29696
    v_and_b32 v8, 15, v6
    v_xor_b32 v8, v8, v2
    v_lshl_add_u32 v21, v8, 4, v7
    v_and_b32 v8, 7, v6
    v_mfma_f32_16x16x32_bf16 v[152:155], v[92:95], v[116:119], v[152:155]
    v_lshlrev_b32 v8, 1, v8
    v_xor_b32 v8, v8, v2
    v_lshl_add_u32 v27, v8, 4, v7
    s_add_u32 s57, s56, 20
    v_mfma_f32_16x16x32_bf16 v[156:159], v[92:95], v[120:123], v[156:159]
    v_add_u32 v6, s57, v3
    v_lshlrev_b32 v7, 8, v6
    v_add_u32 v7, s55, v7
    v_subrev_u32 v7, 1024, v7
    v_mfma_f32_16x16x32_bf16 v[160:163], v[96:99], v[112:115], v[160:163]
    v_and_b32 v8, 15, v6
    v_xor_b32 v8, v8, v2
    v_lshl_add_u32 v22, v8, 4, v7
    v_and_b32 v8, 7, v6
    v_mfma_f32_16x16x32_bf16 v[164:167], v[96:99], v[116:119], v[164:167]
    v_lshlrev_b32 v8, 1, v8
    v_xor_b32 v8, v8, v2
    v_lshl_add_u32 v28, v8, 4, v7
    v_mfma_f32_16x16x32_bf16 v[168:171], v[96:99], v[120:123], v[168:171]
    s_waitcnt lgkmcnt(0)
    ds_read_b128 v[112:115], v38 offset:28672
    ds_read_b128 v[116:119], v38 offset:30720
    s_add_u32 s50, s51, 4
    s_and_b32 s50, s50, 15
    s_lshl_b32 s49, s50, 19
    s_lshl_b32 s50, s50, 7
    s_add_u32 m0, s47, 0
    v_mfma_f32_16x16x32_bf16 v[124:127], v[68:71], v[100:103], v[124:127]
    buffer_load_dwordx4 v10, s[12:15], s49 offen offset:0  lds
    ds_read_b128 v[120:123], v38 offset:32768
    ds_read_b64_tr_b16 v[84:85], v29 offset:36864
    v_mfma_f32_16x16x32_bf16 v[128:131], v[68:71], v[104:107], v[128:131]
    buffer_load_dwordx4 v11, s[12:15], s49 offen offset:1024  lds
    ds_read_b64_tr_b16 v[86:87], v29 offset:37888
    ds_read_b64_tr_b16 v[88:89], v30 offset:36864
    v_mfma_f32_16x16x32_bf16 v[132:135], v[68:71], v[108:111], v[132:135]
    buffer_load_dwordx4 v12, s[12:15], s49 offen offset:2048  lds
    ds_read_b64_tr_b16 v[90:91], v30 offset:37888
    v_mfma_f32_16x16x32_bf16 v[136:139], v[72:75], v[100:103], v[136:139]
    buffer_load_dwordx4 v13, s[12:15], s49 offen offset:3072  lds
    ds_read_b64_tr_b16 v[92:93], v31 offset:36864
    s_add_u32 m0, s48, 0
    v_mfma_f32_16x16x32_bf16 v[140:143], v[72:75], v[104:107], v[140:143]
    buffer_load_dwordx4 v14, s[8:11], s50 offen offset:0  lds
    ds_read_b64_tr_b16 v[94:95], v31 offset:37888
    v_mfma_f32_16x16x32_bf16 v[144:147], v[72:75], v[108:111], v[144:147]
    buffer_load_dwordx4 v15, s[8:11], s50 offen offset:1024  lds
    ds_read_b64_tr_b16 v[96:97], v32 offset:36864
    v_mfma_f32_16x16x32_bf16 v[148:151], v[76:79], v[100:103], v[148:151]
    buffer_load_dwordx4 v16, s[8:11], s50 offen offset:2048  lds
    ds_read_b64_tr_b16 v[98:99], v32 offset:37888
    v_mfma_f32_16x16x32_bf16 v[152:155], v[76:79], v[104:107], v[152:155]
    v_mfma_f32_16x16x32_bf16 v[156:159], v[76:79], v[108:111], v[156:159]
    v_mfma_f32_16x16x32_bf16 v[160:163], v[80:83], v[100:103], v[160:163]
    v_mfma_f32_16x16x32_bf16 v[164:167], v[80:83], v[104:107], v[164:167]
    v_mfma_f32_16x16x32_bf16 v[168:171], v[80:83], v[108:111], v[168:171]
    s_waitcnt vmcnt(14) lgkmcnt(0)
    s_barrier
    s_cmp_eq_u32 s44, 0
    s_cbranch_scc0 L_noadd
    s_getreg_b32 s1, hwreg(HW_REG_XCC_ID)
    s_and_b32 s1, s1, 7
    s_mul_i32 s3, s1, s1
    s_lshl_b32 s3, s3, 16
    s_lshl_b32 s1, s1, 8
    s_add_u32 s1, s1, s3
    s_add_u32 s1, s1, 1
    s_lshl_b32 s3, s40, 2
    s_add_u32 s3, s3, s41
    s_lshl_b32 s3, s3, 2
    v_mov_b32 v56, s3
    v_mov_b32 v57, s1
    s_mov_b64 s[86:87], exec
    s_mov_b64 exec, 1
    buffer_atomic_add v57, v56, s[36:39], 0 offen sc1
    s_mov_b64 exec, s[86:87]
L_noadd:
    ds_read_b128 v[100:103], v39 offset:0
    ds_read_b128 v[104:107], v39 offset:2048
    s_add_u32 s50, s51, 5
    s_and_b32 s50, s50, 15
    s_lshl_b32 s49, s50, 19
    s_lshl_b32 s50, s50, 7
    s_add_u32 m0, s47, 28672
    s_nop 0
    buffer_load_dwordx4 v10, s[12:15], s49 offen offset:0  lds
    buffer_load_dwordx4 v11, s[12:15], s49 offen offset:1024  lds
    v_mfma_f32_16x16x32_bf16 v[124:127], v[84:87], v[112:115], v[124:127]
    buffer_load_dwordx4 v12, s[12:15], s49 offen offset:2048  lds
    ds_read_b128 v[108:111], v39 offset:4096
    ds_read_b64_tr_b16 v[68:69], v33 offset:0
    s_mul_i32 s55, s45, 12288
    v_mfma_f32_16x16x32_bf16 v[128:131], v[84:87], v[116:119], v[128:131]
    buffer_load_dwordx4 v13, s[12:15], s49 offen offset:3072  lds
    ds_read_b64_tr_b16 v[70:71], v33 offset:1024
    ds_read_b64_tr_b16 v[72:73], v34 offset:0
    s_add_u32 s55, s55, 114688
    v_lshlrev_b32 v6, 8, v2
    v_mfma_f32_16x16x32_bf16 v[132:135], v[84:87], v[120:123], v[132:135]
    ds_read_b64_tr_b16 v[74:75], v34 offset:1024
    v_add_u32 v6, s55, v6
    v_and_b32 v7, 1, v3
    v_mfma_f32_16x16x32_bf16 v[136:139], v[88:91], v[112:115], v[136:139]
    ds_read_b64_tr_b16 v[76:77], v35 offset:0
    v_lshl_add_u32 v6, v7, 3, v6
    v_lshrrev_b32 v7, 1, v3
    v_mfma_f32_16x16x32_bf16 v[140:143], v[88:91], v[116:119], v[140:143]
    ds_read_b64_tr_b16 v[78:79], v35 offset:1024
    s_lshl_b32 s56, s46, 3
    v_add_u32 v7, s56, v7
    v_mfma_f32_16x16x32_bf16 v[144:147], v[88:91], v[120:123], v[144:147]
    ds_read_b64_tr_b16 v[80:81], v36 offset:0
    v_xor_b32 v7, v7, v2
    v_xor_b32 v8, 0, v7
    v_mfma_f32_16x16x32_bf16 v[148:151], v[92:95], v[112:115], v[148:151]
    ds_read_b64_tr_b16 v[82:83], v36 offset:1024
    v_lshl_add_u32 v41, v8, 4, v6
    v_xor_b32 v8, 2, v7
    v_mfma_f32_16x16x32_bf16 v[152:155], v[92:95], v[116:119], v[152:155]
    v_lshl_add_u32 v42, v8, 4, v6
    v_xor_b32 v8, 4, v7
    v_mfma_f32_16x16x32_bf16 v[156:159], v[92:95], v[120:123], v[156:159]
    v_lshl_add_u32 v43, v8, 4, v6
    v_xor_b32 v8, 6, v7
    v_mfma_f32_16x16x32_bf16 v[160:163], v[96:99], v[112:115], v[160:163]
    v_lshl_add_u32 v44, v8, 4, v6
    s_mul_i32 s55, s45, 12288
    v_mfma_f32_16x16x32_bf16 v[164:167], v[96:99], v[116:119], v[164:167]
    s_add_u32 s55, s55, 139264
    v_lshl_add_u32 v6, v3, 2, v4
    v_mfma_f32_16x16x32_bf16 v[168:171], v[96:99], v[120:123], v[168:171]
    s_waitcnt lgkmcnt(0)
    ds_read_b128 v[112:115], v40 offset:0
    ds_read_b128 v[116:119], v40 offset:2048
    s_add_u32 m0, s48, 28672
    s_nop 0
    buffer_load_dwordx4 v14, s[8:11], s50 offen offset:0  lds
    v_mfma_f32_16x16x32_bf16 v[124:127], v[68:71], v[100:103], v[124:127]
    buffer_load_dwordx4 v15, s[8:11], s50 offen offset:1024  lds
    ds_read_b128 v[120:123], v40 offset:4096
    ds_read_b64_tr_b16 v[84:85], v33 offset:8192
    v_and_b32 v7, 7, v6
    v_mfma_f32_16x16x32_bf16 v[128:131], v[68:71], v[104:107], v[128:131]
    buffer_load_dwordx4 v16, s[8:11], s50 offen offset:2048  lds
    ds_read_b64_tr_b16 v[86:87], v33 offset:9216
    ds_read_b64_tr_b16 v[88:89], v34 offset:8192
    v_lshlrev_b32 v7, 1, v7
    v_lshlrev_b32 v6, 8, v6
    v_mfma_f32_16x16x32_bf16 v[132:135], v[68:71], v[108:111], v[132:135]
    ds_read_b64_tr_b16 v[90:91], v34 offset:9216
    v_add_u32 v6, s55, v6
    v_and_b32 v8, 1, v5
    v_mfma_f32_16x16x32_bf16 v[136:139], v[72:75], v[100:103], v[136:139]
    ds_read_b64_tr_b16 v[92:93], v35 offset:8192
    v_lshl_add_u32 v6, v8, 3, v6
    v_lshrrev_b32 v8, 1, v5
    v_mfma_f32_16x16x32_bf16 v[140:143], v[72:75], v[104:107], v[140:143]
    ds_read_b64_tr_b16 v[94:95], v35 offset:9216
    v_add_u32 v8, s56, v8
    v_xor_b32 v7, v7, v8
    v_mfma_f32_16x16x32_bf16 v[144:147], v[72:75], v[108:111], v[144:147]
    ds_read_b64_tr_b16 v[96:97], v36 offset:8192
    v_xor_b32 v8, 0, v7
    v_lshl_add_u32 v45, v8, 4, v6
    v_mfma_f32_16x16x32_bf16 v[148:151], v[76:79], v[100:103], v[148:151]
    ds_read_b64_tr_b16 v[98:99], v36 offset:9216
    v_xor_b32 v8, 2, v7
    v_lshl_add_u32 v46, v8, 4, v6
    v_mfma_f32_16x16x32_bf16 v[152:155], v[76:79], v[104:107], v[152:155]
    v_xor_b32 v8, 4, v7
    v_lshl_add_u32 v47, v8, 4, v6
    v_mfma_f32_16x16x32_bf16 v[156:159], v[76:79], v[108:111], v[156:159]
    v_xor_b32 v8, 6, v7
    v_lshl_add_u32 v48, v8, 4, v6
    v_mfma_f32_16x16x32_bf16 v[160:163], v[80:83], v[100:103], v[160:163]
    s_mul_i32 s55, s44, 9216
    s_add_u32 s55, s55, 65536
    v_mfma_f32_16x16x32_bf16 v[164:167], v[80:83], v[104:107], v[164:167]
    v_add_u32 v49, s55, v53
    s_xor_b32 s56, s44, 2
    v_mfma_f32_16x16x32_bf16 v[168:171], v[80:83], v[108:111], v[168:171]
    s_waitcnt vmcnt(14) lgkmcnt(0)
    s_barrier
    ds_read_b128 v[100:103], v39 offset:28672
    ds_read_b128 v[104:107], v39 offset:30720
    s_add_u32 s50, s51, 6
    s_and_b32 s50, s50, 15
    s_lshl_b32 s49, s50, 19
    s_lshl_b32 s50, s50, 7
    s_add_u32 m0, s47, 57344
    s_nop 0
    buffer_load_dwordx4 v10, s[12:15], s49 offen offset:0  lds
    buffer_load_dwordx4 v11, s[12:15], s49 offen offset:1024  lds
    v_mfma_f32_16x16x32_bf16 v[124:127], v[84:87], v[112:115], v[124:127]
    buffer_load_dwordx4 v12, s[12:15], s49 offen offset:2048  lds
    ds_read_b128 v[108:111], v39 offset:32768
    ds_read_b64_tr_b16 v[68:69], v33 offset:28672
    s_mul_i32 s56, s56, 9216
    v_mfma_f32_16x16x32_bf16 v[128:131], v[84:87], v[116:119], v[128:131]
    buffer_load_dwordx4 v13, s[12:15], s49 offen offset:3072  lds
    ds_read_b64_tr_b16 v[70:71], v33 offset:29696
    ds_read_b64_tr_b16 v[72:73], v34 offset:28672
    s_add_u32 s56, s56, 65536
    v_add_u32 v50, s56, v53
    v_mfma_f32_16x16x32_bf16 v[132:135], v[84:87], v[120:123], v[132:135]
    ds_read_b64_tr_b16 v[74:75], v34 offset:29696
    s_lshl_b32 s55, s40, 2
    s_add_u32 s55, s55, s41
    v_mfma_f32_16x16x32_bf16 v[136:139], v[88:91], v[112:115], v[136:139]
    ds_read_b64_tr_b16 v[76:77], v35 offset:28672
    s_lshl_b32 s55, s55, 3
    s_add_u32 s55, s55, s42
    v_mfma_f32_16x16x32_bf16 v[140:143], v[88:91], v[116:119], v[140:143]
    ds_read_b64_tr_b16 v[78:79], v35 offset:29696
    s_mul_i32 s55, s55, 24576
    s_lshl_b32 s56, s45, 2
    v_mfma_f32_16x16x32_bf16 v[144:147], v[88:91], v[120:123], v[144:147]
    ds_read_b64_tr_b16 v[80:81], v36 offset:28672
    s_lshl_b32 s57, s46, 1
    s_add_u32 s56, s56, s57
    v_mfma_f32_16x16x32_bf16 v[148:151], v[92:95], v[112:115], v[148:151]
    ds_read_b64_tr_b16 v[82:83], v36 offset:29696
    s_mul_i32 s56, s56, 3072
    s_add_u32 s55, s55, s56
    v_mfma_f32_16x16x32_bf16 v[152:155], v[92:95], v[116:119], v[152:155]
    v_add_u32 v51, s55, v53
    v_lshl_add_u32 v6, v3, 2, v4
    v_mfma_f32_16x16x32_bf16 v[156:159], v[92:95], v[120:123], v[156:159]
    v_lshlrev_b32 v6, 6, v6
    v_lshl_add_u32 v6, v5, 4, v6
    v_mfma_f32_16x16x32_bf16 v[160:163], v[96:99], v[112:115], v[160:163]
    v_add_u32 v52, s47, v6
    s_lshl_b32 s55, s41, 21
    v_mfma_f32_16x16x32_bf16 v[164:167], v[96:99], v[116:119], v[164:167]
    s_and_b32 s56, s40, 3
    s_lshl_b32 s56, s56, 1
    v_mfma_f32_16x16x32_bf16 v[168:171], v[96:99], v[120:123], v[168:171]
    s_waitcnt lgkmcnt(0)
    ds_read_b128 v[112:115], v40 offset:28672
    ds_read_b128 v[116:119], v40 offset:30720
    s_add_u32 m0, s48, 57344
    s_nop 0
    buffer_load_dwordx4 v14, s[8:11], s50 offen offset:0  lds
    v_mfma_f32_16x16x32_bf16 v[124:127], v[68:71], v[100:103], v[124:127]
    buffer_load_dwordx4 v15, s[8:11], s50 offen offset:1024  lds
    ds_read_b128 v[120:123], v40 offset:32768
    ds_read_b64_tr_b16 v[84:85], v33 offset:36864
    s_lshr_b32 s57, s40, 2
    v_mfma_f32_16x16x32_bf16 v[128:131], v[68:71], v[104:107], v[128:131]
    buffer_load_dwordx4 v16, s[8:11], s50 offen offset:2048  lds
    ds_read_b64_tr_b16 v[86:87], v33 offset:37888
    ds_read_b64_tr_b16 v[88:89], v34 offset:36864
    s_add_u32 s56, s56, s57
    s_lshl_b32 s57, s42, 18
    v_mfma_f32_16x16x32_bf16 v[132:135], v[68:71], v[108:111], v[132:135]
    ds_read_b64_tr_b16 v[90:91], v34 offset:37888
    s_add_u32 s60, s55, s57
    s_add_u32 s57, s56, 0
    v_mfma_f32_16x16x32_bf16 v[136:139], v[72:75], v[100:103], v[136:139]
    ds_read_b64_tr_b16 v[92:93], v35 offset:36864
    s_cmp_ge_u32 s57, 7
    s_cselect_b32 s58, 7, 0
    s_sub_u32 s57, s57, s58
    v_mfma_f32_16x16x32_bf16 v[140:143], v[72:75], v[104:107], v[140:143]
    ds_read_b64_tr_b16 v[94:95], v35 offset:37888
    s_add_u32 s57, s57, s42
    s_add_u32 s57, s57, 1
    v_mfma_f32_16x16x32_bf16 v[144:147], v[72:75], v[108:111], v[144:147]
    ds_read_b64_tr_b16 v[96:97], v36 offset:36864
    s_and_b32 s57, s57, 7
    s_lshl_b32 s57, s57, 18
    v_mfma_f32_16x16x32_bf16 v[148:151], v[76:79], v[100:103], v[148:151]
    ds_read_b64_tr_b16 v[98:99], v36 offset:37888
    s_add_u32 s61, s55, s57
    s_add_u32 s57, s56, 1
    v_mfma_f32_16x16x32_bf16 v[152:155], v[76:79], v[104:107], v[152:155]
    s_cmp_ge_u32 s57, 7
    s_cselect_b32 s58, 7, 0
    s_sub_u32 s57, s57, s58
    v_mfma_f32_16x16x32_bf16 v[156:159], v[76:79], v[108:111], v[156:159]
    s_add_u32 s57, s57, s42
    s_add_u32 s57, s57, 1
    v_mfma_f32_16x16x32_bf16 v[160:163], v[80:83], v[100:103], v[160:163]
    s_and_b32 s57, s57, 7
    s_lshl_b32 s57, s57, 18
    v_mfma_f32_16x16x32_bf16 v[164:167], v[80:83], v[104:107], v[164:167]
    s_add_u32 s62, s55, s57
    s_add_u32 s57, s56, 2
    v_mfma_f32_16x16x32_bf16 v[168:171], v[80:83], v[108:111], v[168:171]
    s_waitcnt vmcnt(14) lgkmcnt(0)
    s_barrier
    ds_read_b128 v[100:103], v37 offset:0
    ds_read_b128 v[104:107], v37 offset:2048
    s_add_u32 s50, s51, 7
    s_and_b32 s50, s50, 15
    s_lshl_b32 s49, s50, 19
    s_lshl_b32 s50, s50, 7
    s_add_u32 m0, s47, 86016
    s_nop 0
    buffer_load_dwordx4 v10, s[12:15], s49 offen offset:0  lds
    buffer_load_dwordx4 v11, s[12:15], s49 offen offset:1024  lds
    v_mfma_f32_16x16x32_bf16 v[124:127], v[84:87], v[112:115], v[124:127]
    buffer_load_dwordx4 v12, s[12:15], s49 offen offset:2048  lds
    ds_read_b128 v[108:111], v37 offset:4096
    ds_read_b64_tr_b16 v[68:69], v29 offset:0
    buffer_load_dwordx4 v13, s[12:15], s49 offen offset:3072  lds
    s_cmp_ge_u32 s57, 7
    s_cselect_b32 s58, 7, 0
    v_mfma_f32_16x16x32_bf16 v[128:131], v[84:87], v[116:119], v[128:131]
    ds_read_b64_tr_b16 v[70:71], v29 offset:1024
    ds_read_b64_tr_b16 v[72:73], v30 offset:0
    s_sub_u32 s57, s57, s58
    s_add_u32 s57, s57, s42
    v_mfma_f32_16x16x32_bf16 v[132:135], v[84:87], v[120:123], v[132:135]
    ds_read_b64_tr_b16 v[74:75], v30 offset:1024
    s_add_u32 s57, s57, 1
    s_and_b32 s57, s57, 7
    v_mfma_f32_16x16x32_bf16 v[136:139], v[88:91], v[112:115], v[136:139]
    ds_read_b64_tr_b16 v[76:77], v31 offset:0
    s_lshl_b32 s57, s57, 18
    s_add_u32 s63, s55, s57
    v_mfma_f32_16x16x32_bf16 v[140:143], v[88:91], v[116:119], v[140:143]
    ds_read_b64_tr_b16 v[78:79], v31 offset:1024
    s_add_u32 s57, s56, 3
    s_cmp_ge_u32 s57, 7
    s_cselect_b32 s58, 7, 0
    v_mfma_f32_16x16x32_bf16 v[144:147], v[88:91], v[120:123], v[144:147]
    ds_read_b64_tr_b16 v[80:81], v32 offset:0
    s_sub_u32 s57, s57, s58
    s_add_u32 s57, s57, s42
    v_mfma_f32_16x16x32_bf16 v[148:151], v[92:95], v[112:115], v[148:151]
    ds_read_b64_tr_b16 v[82:83], v32 offset:1024
    s_add_u32 s57, s57, 1
    s_and_b32 s57, s57, 7
    v_mfma_f32_16x16x32_bf16 v[152:155], v[92:95], v[116:119], v[152:155]
    s_lshl_b32 s57, s57, 18
    s_add_u32 s64, s55, s57
    v_mfma_f32_16x16x32_bf16 v[156:159], v[92:95], v[120:123], v[156:159]
    s_add_u32 s57, s56, 4
    s_cmp_ge_u32 s57, 7
    s_cselect_b32 s58, 7, 0
    v_mfma_f32_16x16x32_bf16 v[160:163], v[96:99], v[112:115], v[160:163]
    s_sub_u32 s57, s57, s58
    s_add_u32 s57, s57, s42
    v_mfma_f32_16x16x32_bf16 v[164:167], v[96:99], v[116:119], v[164:167]
    s_add_u32 s57, s57, 1
    s_and_b32 s57, s57, 7
    v_mfma_f32_16x16x32_bf16 v[168:171], v[96:99], v[120:123], v[168:171]
    s_waitcnt lgkmcnt(0)
    ds_read_b128 v[112:115], v38 offset:0
    ds_read_b128 v[116:119], v38 offset:2048
    s_add_u32 m0, s48, 86016
    s_nop 0
    buffer_load_dwordx4 v14, s[8:11], s50 offen offset:0  lds
    v_mfma_f32_16x16x32_bf16 v[124:127], v[68:71], v[100:103], v[124:127]
    buffer_load_dwordx4 v15, s[8:11], s50 offen offset:1024  lds
    ds_read_b128 v[120:123], v38 offset:4096
    ds_read_b64_tr_b16 v[84:85], v29 offset:8192
    s_lshl_b32 s57, s57, 18
    v_mfma_f32_16x16x32_bf16 v[128:131], v[68:71], v[104:107], v[128:131]
    buffer_load_dwordx4 v16, s[8:11], s50 offen offset:2048  lds
    ds_read_b64_tr_b16 v[86:87], v29 offset:9216
    ds_read_b64_tr_b16 v[88:89], v30 offset:8192
    s_add_u32 s65, s55, s57
    s_add_u32 s57, s56, 5
    v_mfma_f32_16x16x32_bf16 v[132:135], v[68:71], v[108:111], v[132:135]
    ds_read_b64_tr_b16 v[90:91], v30 offset:9216
    s_cmp_ge_u32 s57, 7
    s_cselect_b32 s58, 7, 0
    s_sub_u32 s57, s57, s58
    v_mfma_f32_16x16x32_bf16 v[136:139], v[72:75], v[100:103], v[136:139]
    ds_read_b64_tr_b16 v[92:93], v31 offset:8192
    s_add_u32 s57, s57, s42
    s_add_u32 s57, s57, 1
    v_mfma_f32_16x16x32_bf16 v[140:143], v[72:75], v[104:107], v[140:143]
    ds_read_b64_tr_b16 v[94:95], v31 offset:9216
    s_and_b32 s57, s57, 7
    s_lshl_b32 s57, s57, 18
    v_mfma_f32_16x16x32_bf16 v[144:147], v[72:75], v[108:111], v[144:147]
    ds_read_b64_tr_b16 v[96:97], v32 offset:8192
    s_add_u32 s66, s55, s57
    s_add_u32 s57, s56, 6
    v_mfma_f32_16x16x32_bf16 v[148:151], v[76:79], v[100:103], v[148:151]
    ds_read_b64_tr_b16 v[98:99], v32 offset:9216
    s_cmp_ge_u32 s57, 7
    s_cselect_b32 s58, 7, 0
    s_sub_u32 s57, s57, s58
    v_mfma_f32_16x16x32_bf16 v[152:155], v[76:79], v[104:107], v[152:155]
    s_add_u32 s57, s57, s42
    s_add_u32 s57, s57, 1
    v_mfma_f32_16x16x32_bf16 v[156:159], v[76:79], v[108:111], v[156:159]
    s_and_b32 s57, s57, 7
    v_mfma_f32_16x16x32_bf16 v[160:163], v[80:83], v[100:103], v[160:163]
    s_lshl_b32 s57, s57, 18
    v_mfma_f32_16x16x32_bf16 v[164:167], v[80:83], v[104:107], v[164:167]
    s_add_u32 s67, s55, s57
    v_mfma_f32_16x16x32_bf16 v[168:171], v[80:83], v[108:111], v[168:171]
    s_waitcnt vmcnt(14) lgkmcnt(0)
    s_barrier
    ds_read_b128 v[100:103], v37 offset:28672
    ds_read_b128 v[104:107], v37 offset:30720
    s_add_u32 s50, s51, 8
    s_and_b32 s50, s50, 15
    s_lshl_b32 s49, s50, 19
    s_lshl_b32 s50, s50, 7
    s_add_u32 m0, s47, 0
    s_nop 0
    buffer_load_dwordx4 v10, s[12:15], s49 offen offset:0  lds
    v_mfma_f32_16x16x32_bf16 v[124:127], v[84:87], v[112:115], v[124:127]
    buffer_load_dwordx4 v11, s[12:15], s49 offen offset:1024  lds
    ds_read_b128 v[108:111], v37 offset:32768
    ds_read_b64_tr_b16 v[68:69], v29 offset:28672
    buffer_load_dwordx4 v12, s[12:15], s49 offen offset:2048  lds
    v_mfma_f32_16x16x32_bf16 v[128:131], v[84:87], v[116:119], v[128:131]
    buffer_load_dwordx4 v13, s[12:15], s49 offen offset:3072  lds
    ds_read_b64_tr_b16 v[70:71], v29 offset:29696
    ds_read_b64_tr_b16 v[72:73], v30 offset:28672
    s_lshl_b32 s88, s40, 3
    s_add_u32 s88, s88, s42
    v_mfma_f32_16x16x32_bf16 v[132:135], v[84:87], v[120:123], v[132:135]
    ds_read_b64_tr_b16 v[74:75], v30 offset:29696
    s_lshl_b32 s88, s88, 2
    s_add_u32 s55, s41, 1
    v_mfma_f32_16x16x32_bf16 v[136:139], v[88:91], v[112:115], v[136:139]
    ds_read_b64_tr_b16 v[76:77], v31 offset:28672
    s_and_b32 s55, s55, 3
    s_cmp_ge_u32 s55, 3
    s_cselect_b32 s58, 1, 0
    v_mfma_f32_16x16x32_bf16 v[140:143], v[88:91], v[116:119], v[140:143]
    ds_read_b64_tr_b16 v[78:79], v31 offset:29696
    s_mul_i32 s59, s58, 3
    s_sub_u32 s59, s55, s59
    v_mfma_f32_16x16x32_bf16 v[144:147], v[88:91], v[120:123], v[144:147]
    ds_read_b64_tr_b16 v[80:81], v32 offset:28672
    s_mul_i32 s58, s58, 12288
    s_lshl_b32 s59, s59, 10
    v_mfma_f32_16x16x32_bf16 v[148:151], v[92:95], v[112:115], v[148:151]
    ds_read_b64_tr_b16 v[82:83], v32 offset:29696
    s_add_u32 s68, s58, s59
    s_add_u32 s58, s88, s55
    v_mfma_f32_16x16x32_bf16 v[152:155], v[92:95], v[116:119], v[152:155]
    s_lshl_b32 s59, s58, 2
    s_add_u32 s59, s59, s41
    v_mfma_f32_16x16x32_bf16 v[156:159], v[92:95], v[120:123], v[156:159]
    s_mul_i32 s59, s59, 12288
    s_lshl_b32 s74, s44, 11
    v_mfma_f32_16x16x32_bf16 v[160:163], v[96:99], v[112:115], v[160:163]
    s_add_u32 s74, s74, 6291456
    s_add_u32 s74, s74, s59
    v_mfma_f32_16x16x32_bf16 v[164:167], v[96:99], v[116:119], v[164:167]
    s_lshl_b32 s59, s58, 10
    v_mfma_f32_16x16x32_bf16 v[168:171], v[96:99], v[120:123], v[168:171]
    s_waitcnt lgkmcnt(0)
    ds_read_b128 v[112:115], v38 offset:28672
    ds_read_b128 v[116:119], v38 offset:30720
    s_xor_b32 s86, s42, 1
    s_lshl_b32 s86, s86, 8
    s_lshl_b32 s87, s41, 21
    s_add_u32 s86, s86, s87
    s_lshl_b32 s87, s40, 18
    s_add_u32 s86, s86, s87
    s_mul_i32 s87, s44, 65536
    s_add_u32 s86, s86, s87
    v_lshrrev_b32 v176, 1, v1
    v_lshlrev_b32 v176, 11, v176
    v_and_b32 v177, 1, v1
    v_lshlrev_b32 v177, 7, v177
    v_add_u32 v176, v176, v177
    v_add_u32 v176, s86, v176
    s_add_u32 m0, s48, 0
    v_mfma_f32_16x16x32_bf16 v[124:127], v[68:71], v[100:103], v[124:127]
    buffer_load_dwordx4 v14, s[8:11], s50 offen offset:0  lds
    ds_read_b128 v[120:123], v38 offset:32768
    ds_read_b64_tr_b16 v[84:85], v29 offset:36864
    buffer_load_dwordx4 v15, s[8:11], s50 offen offset:1024  lds
    v_mfma_f32_16x16x32_bf16 v[128:131], v[68:71], v[104:107], v[128:131]
    buffer_load_dwordx4 v16, s[8:11], s50 offen offset:2048  lds
    ds_read_b64_tr_b16 v[86:87], v29 offset:37888
    ds_read_b64_tr_b16 v[88:89], v30 offset:36864
    s_mov_b32 exec_lo, 0xffffffff
    s_mov_b32 exec_hi, 0x0
    buffer_load_dword a252, v176, s[28:31], 0 offen
    s_mov_b64 exec, -1
    s_and_b32 s58, s44, 1
    v_mfma_f32_16x16x32_bf16 v[132:135], v[68:71], v[108:111], v[132:135]
    ds_read_b64_tr_b16 v[90:91], v30 offset:37888
    s_lshl_b32 s58, s58, 7
    s_add_u32 s59, s59, s58
    v_mfma_f32_16x16x32_bf16 v[136:139], v[72:75], v[100:103], v[136:139]
    ds_read_b64_tr_b16 v[92:93], v31 offset:36864
    s_lshr_b32 s58, s44, 1
    s_lshl_b32 s58, s58, 9
    v_mfma_f32_16x16x32_bf16 v[140:143], v[72:75], v[104:107], v[140:143]
    ds_read_b64_tr_b16 v[94:95], v31 offset:37888
    s_add_u32 s59, s59, s58
    s_lshl_b32 s58, s41, 2
    v_mfma_f32_16x16x32_bf16 v[144:147], v[72:75], v[108:111], v[144:147]
    ds_read_b64_tr_b16 v[96:97], v32 offset:36864
    s_add_u32 s59, s59, s58
    s_add_u32 s4, s59, 21037056
    v_mfma_f32_16x16x32_bf16 v[148:151], v[76:79], v[100:103], v[148:151]
    ds_read_b64_tr_b16 v[98:99], v32 offset:37888
    s_add_u32 s55, s41, 2
    s_and_b32 s55, s55, 3
    v_mfma_f32_16x16x32_bf16 v[152:155], v[76:79], v[104:107], v[152:155]
    s_cmp_ge_u32 s55, 3
    s_cselect_b32 s58, 1, 0
    s_mul_i32 s59, s58, 3
    v_mfma_f32_16x16x32_bf16 v[156:159], v[76:79], v[108:111], v[156:159]
    s_sub_u32 s59, s55, s59
    s_mul_i32 s58, s58, 12288
    v_mfma_f32_16x16x32_bf16 v[160:163], v[80:83], v[100:103], v[160:163]
    s_lshl_b32 s59, s59, 10
    s_add_u32 s69, s58, s59
    v_mfma_f32_16x16x32_bf16 v[164:167], v[80:83], v[104:107], v[164:167]
    s_add_u32 s58, s88, s55
    s_lshl_b32 s59, s58, 2
    v_mfma_f32_16x16x32_bf16 v[168:171], v[80:83], v[108:111], v[168:171]
    s_waitcnt vmcnt(15) lgkmcnt(0)
    s_barrier
    ds_read_b128 v[100:103], v39 offset:0
    ds_read_b128 v[104:107], v39 offset:2048
    s_add_u32 s50, s51, 9
    s_and_b32 s50, s50, 15
    s_lshl_b32 s49, s50, 19
    s_lshl_b32 s50, s50, 7
    s_add_u32 m0, s47, 28672
    s_nop 0
    buffer_load_dwordx4 v10, s[12:15], s49 offen offset:0  lds
    v_mfma_f32_16x16x32_bf16 v[124:127], v[84:87], v[112:115], v[124:127]
    buffer_load_dwordx4 v11, s[12:15], s49 offen offset:1024  lds
    ds_read_b128 v[108:111], v39 offset:4096
    ds_read_b64_tr_b16 v[68:69], v33 offset:0
    buffer_load_dwordx4 v12, s[12:15], s49 offen offset:2048  lds
    v_mfma_f32_16x16x32_bf16 v[128:131], v[84:87], v[116:119], v[128:131]
    buffer_load_dwordx4 v13, s[12:15], s49 offen offset:3072  lds
    ds_read_b64_tr_b16 v[70:71], v33 offset:1024
    ds_read_b64_tr_b16 v[72:73], v34 offset:0
    s_add_u32 s59, s59, s41
    s_mul_i32 s59, s59, 12288
    v_mfma_f32_16x16x32_bf16 v[132:135], v[84:87], v[120:123], v[132:135]
    ds_read_b64_tr_b16 v[74:75], v34 offset:1024
    s_lshl_b32 s75, s44, 11
    s_add_u32 s75, s75, 6291456
    v_mfma_f32_16x16x32_bf16 v[136:139], v[88:91], v[112:115], v[136:139]
    ds_read_b64_tr_b16 v[76:77], v35 offset:0
    s_add_u32 s75, s75, s59
    s_lshl_b32 s59, s58, 10
    v_mfma_f32_16x16x32_bf16 v[140:143], v[88:91], v[116:119], v[140:143]
    ds_read_b64_tr_b16 v[78:79], v35 offset:1024
    s_and_b32 s58, s44, 1
    s_lshl_b32 s58, s58, 7
    v_mfma_f32_16x16x32_bf16 v[144:147], v[88:91], v[120:123], v[144:147]
    ds_read_b64_tr_b16 v[80:81], v36 offset:0
    s_add_u32 s59, s59, s58
    s_lshr_b32 s58, s44, 1
    v_mfma_f32_16x16x32_bf16 v[148:151], v[92:95], v[112:115], v[148:151]
    ds_read_b64_tr_b16 v[82:83], v36 offset:1024
    s_lshl_b32 s58, s58, 9
    s_add_u32 s59, s59, s58
    v_mfma_f32_16x16x32_bf16 v[152:155], v[92:95], v[116:119], v[152:155]
    s_lshl_b32 s58, s41, 2
    s_add_u32 s59, s59, s58
    v_mfma_f32_16x16x32_bf16 v[156:159], v[92:95], v[120:123], v[156:159]
    s_add_u32 s5, s59, 21037056
    s_add_u32 s55, s41, 3
    v_mfma_f32_16x16x32_bf16 v[160:163], v[96:99], v[112:115], v[160:163]
    s_and_b32 s55, s55, 3
    s_cmp_ge_u32 s55, 3
    s_cselect_b32 s58, 1, 0
    v_mfma_f32_16x16x32_bf16 v[164:167], v[96:99], v[116:119], v[164:167]
    s_mul_i32 s59, s58, 3
    v_mfma_f32_16x16x32_bf16 v[168:171], v[96:99], v[120:123], v[168:171]
    s_waitcnt lgkmcnt(0)
    ds_read_b128 v[112:115], v40 offset:0
    ds_read_b128 v[116:119], v40 offset:2048
    s_add_u32 m0, s48, 28672
    s_nop 0
    buffer_load_dwordx4 v14, s[8:11], s50 offen offset:0  lds
    v_mfma_f32_16x16x32_bf16 v[124:127], v[68:71], v[100:103], v[124:127]
    buffer_load_dwordx4 v15, s[8:11], s50 offen offset:1024  lds
    ds_read_b128 v[120:123], v40 offset:4096
    ds_read_b64_tr_b16 v[84:85], v33 offset:8192
    s_sub_u32 s59, s55, s59
    v_mfma_f32_16x16x32_bf16 v[128:131], v[68:71], v[104:107], v[128:131]
    buffer_load_dwordx4 v16, s[8:11], s50 offen offset:2048  lds
    ds_read_b64_tr_b16 v[86:87], v33 offset:9216
    ds_read_b64_tr_b16 v[88:89], v34 offset:8192
    s_mul_i32 s58, s58, 12288
    s_lshl_b32 s59, s59, 10
    v_mfma_f32_16x16x32_bf16 v[132:135], v[68:71], v[108:111], v[132:135]
    ds_read_b64_tr_b16 v[90:91], v34 offset:9216
    s_add_u32 s70, s58, s59
    s_add_u32 s58, s88, s55
    v_mfma_f32_16x16x32_bf16 v[136:139], v[72:75], v[100:103], v[136:139]
    ds_read_b64_tr_b16 v[92:93], v35 offset:8192
    s_lshl_b32 s59, s58, 2
    s_add_u32 s59, s59, s41
    v_mfma_f32_16x16x32_bf16 v[140:143], v[72:75], v[104:107], v[140:143]
    ds_read_b64_tr_b16 v[94:95], v35 offset:9216
    s_mul_i32 s59, s59, 12288
    s_lshl_b32 s76, s44, 11
    v_mfma_f32_16x16x32_bf16 v[144:147], v[72:75], v[108:111], v[144:147]
    ds_read_b64_tr_b16 v[96:97], v36 offset:8192
    s_add_u32 s76, s76, 6291456
    s_add_u32 s76, s76, s59
    v_mfma_f32_16x16x32_bf16 v[148:151], v[76:79], v[100:103], v[148:151]
    ds_read_b64_tr_b16 v[98:99], v36 offset:9216
    s_lshl_b32 s59, s58, 10
    s_and_b32 s58, s44, 1
    v_mfma_f32_16x16x32_bf16 v[152:155], v[76:79], v[104:107], v[152:155]
    s_lshl_b32 s58, s58, 7
    s_add_u32 s59, s59, s58
    v_mfma_f32_16x16x32_bf16 v[156:159], v[76:79], v[108:111], v[156:159]
    s_lshr_b32 s58, s44, 1
    s_lshl_b32 s58, s58, 9
    v_mfma_f32_16x16x32_bf16 v[160:163], v[80:83], v[100:103], v[160:163]
    s_add_u32 s59, s59, s58
    v_mfma_f32_16x16x32_bf16 v[164:167], v[80:83], v[104:107], v[164:167]
    s_lshl_b32 s58, s41, 2
    v_mfma_f32_16x16x32_bf16 v[168:171], v[80:83], v[108:111], v[168:171]
    s_waitcnt vmcnt(15) lgkmcnt(0)
    s_barrier
    ds_read_b128 v[100:103], v39 offset:28672
    ds_read_b128 v[104:107], v39 offset:30720
    s_add_u32 s50, s51, 10
    s_and_b32 s50, s50, 15
    s_lshl_b32 s49, s50, 19
    s_lshl_b32 s50, s50, 7
    s_add_u32 m0, s47, 57344
    s_nop 0
    buffer_load_dwordx4 v10, s[12:15], s49 offen offset:0  lds
    v_mfma_f32_16x16x32_bf16 v[124:127], v[84:87], v[112:115], v[124:127]
    buffer_load_dwordx4 v11, s[12:15], s49 offen offset:1024  lds
    ds_read_b128 v[108:111], v39 offset:32768
    ds_read_b64_tr_b16 v[68:69], v33 offset:28672
    buffer_load_dwordx4 v12, s[12:15], s49 offen offset:2048  lds
    v_mfma_f32_16x16x32_bf16 v[128:131], v[84:87], v[116:119], v[128:131]
    buffer_load_dwordx4 v13, s[12:15], s49 offen offset:3072  lds
    ds_read_b64_tr_b16 v[70:71], v33 offset:29696
    ds_read_b64_tr_b16 v[72:73], v34 offset:28672
    s_add_u32 s59, s59, s58
    s_add_u32 s0, s59, 21037056
    v_mfma_f32_16x16x32_bf16 v[132:135], v[84:87], v[120:123], v[132:135]
    ds_read_b64_tr_b16 v[74:75], v34 offset:29696
    s_lshr_b32 s55, s41, 1
    s_xor_b32 s55, s55, 1
    v_mfma_f32_16x16x32_bf16 v[136:139], v[88:91], v[112:115], v[136:139]
    ds_read_b64_tr_b16 v[76:77], v35 offset:28672
    s_add_u32 s56, s55, 4
    s_cmp_ge_u32 s56, 3
    s_cselect_b32 s58, 1, 0
    v_mfma_f32_16x16x32_bf16 v[140:143], v[88:91], v[116:119], v[140:143]
    ds_read_b64_tr_b16 v[78:79], v35 offset:29696
    s_mul_i32 s59, s58, 3
    s_sub_u32 s59, s56, s59
    v_mfma_f32_16x16x32_bf16 v[144:147], v[88:91], v[120:123], v[144:147]
    ds_read_b64_tr_b16 v[80:81], v36 offset:28672
    s_mul_i32 s58, s58, 12288
    s_lshl_b32 s59, s59, 10
    v_mfma_f32_16x16x32_bf16 v[148:151], v[92:95], v[112:115], v[148:151]
    ds_read_b64_tr_b16 v[82:83], v36 offset:29696
    s_add_u32 s71, s58, s59
    s_lshl_b32 s55, s55, 1
    v_mfma_f32_16x16x32_bf16 v[152:155], v[92:95], v[116:119], v[152:155]
    s_lshr_b32 s56, s44, 1
    s_add_u32 s55, s55, s56
    v_mfma_f32_16x16x32_bf16 v[156:159], v[92:95], v[120:123], v[156:159]
    s_add_u32 s58, s88, s55
    s_lshl_b32 s59, s58, 2
    v_mfma_f32_16x16x32_bf16 v[160:163], v[96:99], v[112:115], v[160:163]
    s_add_u32 s59, s59, s41
    s_mul_i32 s59, s59, 12288
    v_mfma_f32_16x16x32_bf16 v[164:167], v[96:99], v[116:119], v[164:167]
    s_and_b32 s77, s44, 1
    v_mfma_f32_16x16x32_bf16 v[168:171], v[96:99], v[120:123], v[168:171]
    s_waitcnt lgkmcnt(0)
    ds_read_b128 v[112:115], v40 offset:28672
    ds_read_b128 v[116:119], v40 offset:30720
    s_add_u32 m0, s48, 57344
    s_nop 0
    buffer_load_dwordx4 v14, s[8:11], s50 offen offset:0  lds
    v_mfma_f32_16x16x32_bf16 v[124:127], v[68:71], v[100:103], v[124:127]
    buffer_load_dwordx4 v15, s[8:11], s50 offen offset:1024  lds
    ds_read_b128 v[120:123], v40 offset:32768
    ds_read_b64_tr_b16 v[84:85], v33 offset:36864
    buffer_load_dwordx4 v16, s[8:11], s50 offen offset:2048  lds
    s_mov_b32 exec_lo, 0x0
    s_mov_b32 exec_hi, 0xffffffff
    buffer_load_dword a252, v176, s[28:31], 0 offen
    s_mov_b64 exec, -1
    v_mfma_f32_16x16x32_bf16 v[128:131], v[68:71], v[104:107], v[128:131]
    ds_read_b64_tr_b16 v[86:87], v33 offset:37888
    ds_read_b64_tr_b16 v[88:89], v34 offset:36864
    s_lshl_b32 s77, s77, 11
    s_add_u32 s77, s77, 6299648
    v_mfma_f32_16x16x32_bf16 v[132:135], v[68:71], v[108:111], v[132:135]
    ds_read_b64_tr_b16 v[90:91], v34 offset:37888
    s_add_u32 s77, s77, s59
    s_lshr_b32 s55, s41, 1
    v_mfma_f32_16x16x32_bf16 v[136:139], v[72:75], v[100:103], v[136:139]
    ds_read_b64_tr_b16 v[92:93], v35 offset:36864
    s_add_u32 s56, s55, 4
    s_cmp_ge_u32 s56, 3
    s_cselect_b32 s58, 1, 0
    v_mfma_f32_16x16x32_bf16 v[140:143], v[72:75], v[104:107], v[140:143]
    ds_read_b64_tr_b16 v[94:95], v35 offset:37888
    s_mul_i32 s59, s58, 3
    s_sub_u32 s59, s56, s59
    v_mfma_f32_16x16x32_bf16 v[144:147], v[72:75], v[108:111], v[144:147]
    ds_read_b64_tr_b16 v[96:97], v36 offset:36864
    s_mul_i32 s58, s58, 12288
    s_lshl_b32 s59, s59, 10
    v_mfma_f32_16x16x32_bf16 v[148:151], v[76:79], v[100:103], v[148:151]
    ds_read_b64_tr_b16 v[98:99], v36 offset:37888
    s_add_u32 s72, s58, s59
    s_lshl_b32 s55, s55, 1
    v_mfma_f32_16x16x32_bf16 v[152:155], v[76:79], v[104:107], v[152:155]
    s_lshr_b32 s56, s44, 1
    s_add_u32 s55, s55, s56
    v_mfma_f32_16x16x32_bf16 v[156:159], v[76:79], v[108:111], v[156:159]
    s_add_u32 s58, s88, s55
    s_lshl_b32 s59, s58, 2
    v_mfma_f32_16x16x32_bf16 v[160:163], v[80:83], v[100:103], v[160:163]
    s_add_u32 s59, s59, s41
    s_mul_i32 s59, s59, 12288
    v_mfma_f32_16x16x32_bf16 v[164:167], v[80:83], v[104:107], v[164:167]
    s_and_b32 s78, s44, 1
    v_mfma_f32_16x16x32_bf16 v[168:171], v[80:83], v[108:111], v[168:171]
    s_waitcnt vmcnt(16) lgkmcnt(0)
    s_barrier
    ds_read_b128 v[100:103], v37 offset:0
    ds_read_b128 v[104:107], v37 offset:2048
    s_add_u32 s50, s51, 11
    s_and_b32 s50, s50, 15
    s_lshl_b32 s49, s50, 19
    s_lshl_b32 s50, s50, 7
    s_add_u32 m0, s47, 86016
    s_nop 0
    buffer_load_dwordx4 v10, s[12:15], s49 offen offset:0  lds
    v_mfma_f32_16x16x32_bf16 v[124:127], v[84:87], v[112:115], v[124:127]
    buffer_load_dwordx4 v11, s[12:15], s49 offen offset:1024  lds
    ds_read_b128 v[108:111], v37 offset:4096
    ds_read_b64_tr_b16 v[68:69], v29 offset:0
    buffer_load_dwordx4 v12, s[12:15], s49 offen offset:2048  lds
    v_mfma_f32_16x16x32_bf16 v[128:131], v[84:87], v[116:119], v[128:131]
    buffer_load_dwordx4 v13, s[12:15], s49 offen offset:3072  lds
    ds_read_b64_tr_b16 v[70:71], v29 offset:1024
    ds_read_b64_tr_b16 v[72:73], v30 offset:0
    s_lshl_b32 s78, s78, 11
    s_add_u32 s78, s78, 6299648
    v_mfma_f32_16x16x32_bf16 v[132:135], v[84:87], v[120:123], v[132:135]
    ds_read_b64_tr_b16 v[74:75], v30 offset:1024
    s_add_u32 s78, s78, s59
    s_cmp_ge_u32 s41, 3
    s_cselect_b32 s58, 1, 0
    v_mfma_f32_16x16x32_bf16 v[136:139], v[88:91], v[112:115], v[136:139]
    ds_read_b64_tr_b16 v[76:77], v31 offset:0
    s_mul_i32 s59, s58, 3
    s_sub_u32 s59, s41, s59
    v_mfma_f32_16x16x32_bf16 v[140:143], v[88:91], v[116:119], v[140:143]
    ds_read_b64_tr_b16 v[78:79], v31 offset:1024
    s_mul_i32 s58, s58, 12288
    s_lshl_b32 s59, s59, 10
    v_mfma_f32_16x16x32_bf16 v[144:147], v[88:91], v[120:123], v[144:147]
    ds_read_b64_tr_b16 v[80:81], v32 offset:0
    s_add_u32 s73, s58, s59
    s_lshl_b32 s3, s40, 2
    v_mfma_f32_16x16x32_bf16 v[148:151], v[92:95], v[112:115], v[148:151]
    ds_read_b64_tr_b16 v[82:83], v32 offset:1024
    s_add_u32 s3, s3, s41
    s_lshl_b32 s3, s3, 3
    v_mfma_f32_16x16x32_bf16 v[152:155], v[92:95], v[116:119], v[152:155]
    s_lshl_b32 s55, s45, 2
    s_lshl_b32 s56, s46, 1
    v_mfma_f32_16x16x32_bf16 v[156:159], v[92:95], v[120:123], v[156:159]
    s_add_u32 s55, s55, s56
    s_mul_i32 s55, s55, 3072
    v_mfma_f32_16x16x32_bf16 v[160:163], v[96:99], v[112:115], v[160:163]
    s_add_u32 s55, s55, 114688
    v_add_u32 v62, s55, v53
    v_mfma_f32_16x16x32_bf16 v[164:167], v[96:99], v[116:119], v[164:167]
    s_lshl_b32 s55, s40, 2
    v_mfma_f32_16x16x32_bf16 v[168:171], v[96:99], v[120:123], v[168:171]
    s_waitcnt lgkmcnt(0)
    ds_read_b128 v[112:115], v38 offset:0
    ds_read_b128 v[116:119], v38 offset:2048
    s_add_u32 m0, s48, 86016
    s_nop 0
    buffer_load_dwordx4 v14, s[8:11], s50 offen offset:0  lds
    v_mfma_f32_16x16x32_bf16 v[124:127], v[68:71], v[100:103], v[124:127]
    buffer_load_dwordx4 v15, s[8:11], s50 offen offset:1024  lds
    ds_read_b128 v[120:123], v38 offset:4096
    ds_read_b64_tr_b16 v[84:85], v29 offset:8192
    s_add_u32 s55, s55, s41
    v_mfma_f32_16x16x32_bf16 v[128:131], v[68:71], v[104:107], v[128:131]
    buffer_load_dwordx4 v16, s[8:11], s50 offen offset:2048  lds
    ds_read_b64_tr_b16 v[86:87], v29 offset:9216
    ds_read_b64_tr_b16 v[88:89], v30 offset:8192
    s_lshl_b32 s55, s55, 10
    s_add_u32 s55, s55, 20971520
    v_mfma_f32_16x16x32_bf16 v[132:135], v[68:71], v[108:111], v[132:135]
    ds_read_b64_tr_b16 v[90:91], v30 offset:9216
    v_and_b32 v60, 31, v1
    v_lshlrev_b32 v60, 2, v60
    v_mfma_f32_16x16x32_bf16 v[136:139], v[72:75], v[100:103], v[136:139]
    ds_read_b64_tr_b16 v[92:93], v31 offset:8192
    v_add_u32 v60, s55, v60
    v_mfma_f32_16x16x32_bf16 v[140:143], v[72:75], v[104:107], v[140:143]
    ds_read_b64_tr_b16 v[94:95], v31 offset:9216
    v_mov_b32 v61, 1
    v_mfma_f32_16x16x32_bf16 v[144:147], v[72:75], v[108:111], v[144:147]
    ds_read_b64_tr_b16 v[96:97], v32 offset:8192
    v_add_u32 v63, 0x10000, v53
    v_mfma_f32_16x16x32_bf16 v[148:151], v[76:79], v[100:103], v[148:151]
    ds_read_b64_tr_b16 v[98:99], v32 offset:9216
    v_add_u32 v64, 0x20000, v53
    v_mfma_f32_16x16x32_bf16 v[152:155], v[76:79], v[104:107], v[152:155]
    v_and_b32 v65, 3, v1
    v_mfma_f32_16x16x32_bf16 v[156:159], v[76:79], v[108:111], v[156:159]
    v_lshlrev_b32 v65, 2, v65
    v_mfma_f32_16x16x32_bf16 v[160:163], v[80:83], v[100:103], v[160:163]
    s_lshl_b32 s55, s40, 4
    v_mfma_f32_16x16x32_bf16 v[164:167], v[80:83], v[104:107], v[164:167]
    v_add_u32 v65, s55, v65
    v_mfma_f32_16x16x32_bf16 v[168:171], v[80:83], v[108:111], v[168:171]
    s_waitcnt vmcnt(15) lgkmcnt(0)
    s_barrier
    ds_read_b128 v[100:103], v37 offset:28672
    ds_read_b128 v[104:107], v37 offset:30720
    s_add_u32 s50, s51, 12
    s_and_b32 s50, s50, 15
    s_lshl_b32 s49, s50, 19
    s_lshl_b32 s50, s50, 7
    s_add_u32 m0, s47, 0
    v_mfma_f32_16x16x32_bf16 v[124:127], v[84:87], v[112:115], v[124:127]
    buffer_load_dwordx4 v10, s[12:15], s49 offen offset:0  lds
    ds_read_b128 v[108:111], v37 offset:32768
    ds_read_b64_tr_b16 v[68:69], v29 offset:28672
    v_mfma_f32_16x16x32_bf16 v[128:131], v[84:87], v[116:119], v[128:131]
    buffer_load_dwordx4 v11, s[12:15], s49 offen offset:1024  lds
    ds_read_b64_tr_b16 v[70:71], v29 offset:29696
    ds_read_b64_tr_b16 v[72:73], v30 offset:28672
    v_mfma_f32_16x16x32_bf16 v[132:135], v[84:87], v[120:123], v[132:135]
    buffer_load_dwordx4 v12, s[12:15], s49 offen offset:2048  lds
    ds_read_b64_tr_b16 v[74:75], v30 offset:29696
    v_mfma_f32_16x16x32_bf16 v[136:139], v[88:91], v[112:115], v[136:139]
    buffer_load_dwordx4 v13, s[12:15], s49 offen offset:3072  lds
    ds_read_b64_tr_b16 v[76:77], v31 offset:28672
    v_mfma_f32_16x16x32_bf16 v[140:143], v[88:91], v[116:119], v[140:143]
    ds_read_b64_tr_b16 v[78:79], v31 offset:29696
    v_mfma_f32_16x16x32_bf16 v[144:147], v[88:91], v[120:123], v[144:147]
    ds_read_b64_tr_b16 v[80:81], v32 offset:28672
    v_mfma_f32_16x16x32_bf16 v[148:151], v[92:95], v[112:115], v[148:151]
    ds_read_b64_tr_b16 v[82:83], v32 offset:29696
    v_mfma_f32_16x16x32_bf16 v[152:155], v[92:95], v[116:119], v[152:155]
    v_mfma_f32_16x16x32_bf16 v[156:159], v[92:95], v[120:123], v[156:159]
    v_mfma_f32_16x16x32_bf16 v[160:163], v[96:99], v[112:115], v[160:163]
    v_mfma_f32_16x16x32_bf16 v[164:167], v[96:99], v[116:119], v[164:167]
    v_mfma_f32_16x16x32_bf16 v[168:171], v[96:99], v[120:123], v[168:171]
    s_waitcnt lgkmcnt(0)
    ds_read_b128 v[112:115], v38 offset:28672
    ds_read_b128 v[116:119], v38 offset:30720
    s_add_u32 m0, s48, 0
    v_mfma_f32_16x16x32_bf16 v[124:127], v[68:71], v[100:103], v[124:127]
    buffer_load_dwordx4 v14, s[8:11], s50 offen offset:0  lds
    ds_read_b128 v[120:123], v38 offset:32768
    ds_read_b64_tr_b16 v[84:85], v29 offset:36864
    v_mfma_f32_16x16x32_bf16 v[128:131], v[68:71], v[104:107], v[128:131]
    buffer_load_dwordx4 v15, s[8:11], s50 offen offset:1024  lds
    ds_read_b64_tr_b16 v[86:87], v29 offset:37888
    ds_read_b64_tr_b16 v[88:89], v30 offset:36864
    v_mfma_f32_16x16x32_bf16 v[132:135], v[68:71], v[108:111], v[132:135]
    buffer_load_dwordx4 v16, s[8:11], s50 offen offset:2048  lds
    ds_read_b64_tr_b16 v[90:91], v30 offset:37888
    v_mfma_f32_16x16x32_bf16 v[136:139], v[72:75], v[100:103], v[136:139]
    ds_read_b64_tr_b16 v[92:93], v31 offset:36864
    v_mfma_f32_16x16x32_bf16 v[140:143], v[72:75], v[104:107], v[140:143]
    ds_read_b64_tr_b16 v[94:95], v31 offset:37888
    v_mfma_f32_16x16x32_bf16 v[144:147], v[72:75], v[108:111], v[144:147]
    ds_read_b64_tr_b16 v[96:97], v32 offset:36864
    v_mfma_f32_16x16x32_bf16 v[148:151], v[76:79], v[100:103], v[148:151]
    ds_read_b64_tr_b16 v[98:99], v32 offset:37888
    v_mfma_f32_16x16x32_bf16 v[152:155], v[76:79], v[104:107], v[152:155]
    v_mfma_f32_16x16x32_bf16 v[156:159], v[76:79], v[108:111], v[156:159]
    v_mfma_f32_16x16x32_bf16 v[160:163], v[80:83], v[100:103], v[160:163]
    v_mfma_f32_16x16x32_bf16 v[164:167], v[80:83], v[104:107], v[164:167]
    v_mfma_f32_16x16x32_bf16 v[168:171], v[80:83], v[108:111], v[168:171]
    s_waitcnt vmcnt(15) lgkmcnt(0)
    s_barrier
    ds_read_b128 v[100:103], v39 offset:0
    ds_read_b128 v[104:107], v39 offset:2048
    s_add_u32 s50, s51, 13
    s_and_b32 s50, s50, 15
    s_lshl_b32 s49, s50, 19
    s_lshl_b32 s50, s50, 7
    s_add_u32 m0, s47, 28672
    v_mfma_f32_16x16x32_bf16 v[124:127], v[84:87], v[112:115], v[124:127]
    buffer_load_dwordx4 v10, s[12:15], s49 offen offset:0  lds
    ds_read_b128 v[108:111], v39 offset:4096
    ds_read_b64_tr_b16 v[68:69], v33 offset:0
    v_mfma_f32_16x16x32_bf16 v[128:131], v[84:87], v[116:119], v[128:131]
    buffer_load_dwordx4 v11, s[12:15], s49 offen offset:1024  lds
    ds_read_b64_tr_b16 v[70:71], v33 offset:1024
    ds_read_b64_tr_b16 v[72:73], v34 offset:0
    v_mfma_f32_16x16x32_bf16 v[132:135], v[84:87], v[120:123], v[132:135]
    buffer_load_dwordx4 v12, s[12:15], s49 offen offset:2048  lds
    ds_read_b64_tr_b16 v[74:75], v34 offset:1024
    v_mfma_f32_16x16x32_bf16 v[136:139], v[88:91], v[112:115], v[136:139]
    buffer_load_dwordx4 v13, s[12:15], s49 offen offset:3072  lds
    ds_read_b64_tr_b16 v[76:77], v35 offset:0
    v_mfma_f32_16x16x32_bf16 v[140:143], v[88:91], v[116:119], v[140:143]
    ds_read_b64_tr_b16 v[78:79], v35 offset:1024
    v_mfma_f32_16x16x32_bf16 v[144:147], v[88:91], v[120:123], v[144:147]
    ds_read_b64_tr_b16 v[80:81], v36 offset:0
    v_mfma_f32_16x16x32_bf16 v[148:151], v[92:95], v[112:115], v[148:151]
    ds_read_b64_tr_b16 v[82:83], v36 offset:1024
    v_mfma_f32_16x16x32_bf16 v[152:155], v[92:95], v[116:119], v[152:155]
    v_mfma_f32_16x16x32_bf16 v[156:159], v[92:95], v[120:123], v[156:159]
    v_mfma_f32_16x16x32_bf16 v[160:163], v[96:99], v[112:115], v[160:163]
    v_mfma_f32_16x16x32_bf16 v[164:167], v[96:99], v[116:119], v[164:167]
    v_mfma_f32_16x16x32_bf16 v[168:171], v[96:99], v[120:123], v[168:171]
    s_waitcnt lgkmcnt(0)
    ds_read_b128 v[112:115], v40 offset:0
    ds_read_b128 v[116:119], v40 offset:2048
    s_add_u32 m0, s48, 28672
    v_mfma_f32_16x16x32_bf16 v[124:127], v[68:71], v[100:103], v[124:127]
    buffer_load_dwordx4 v14, s[8:11], s50 offen offset:0  lds
    ds_read_b128 v[120:123], v40 offset:4096
    ds_read_b64_tr_b16 v[84:85], v33 offset:8192
    v_mfma_f32_16x16x32_bf16 v[128:131], v[68:71], v[104:107], v[128:131]
    buffer_load_dwordx4 v15, s[8:11], s50 offen offset:1024  lds
    ds_read_b64_tr_b16 v[86:87], v33 offset:9216
    ds_read_b64_tr_b16 v[88:89], v34 offset:8192
    v_mfma_f32_16x16x32_bf16 v[132:135], v[68:71], v[108:111], v[132:135]
    buffer_load_dwordx4 v16, s[8:11], s50 offen offset:2048  lds
    ds_read_b64_tr_b16 v[90:91], v34 offset:9216
    v_mfma_f32_16x16x32_bf16 v[136:139], v[72:75], v[100:103], v[136:139]
    ds_read_b64_tr_b16 v[92:93], v35 offset:8192
    v_mfma_f32_16x16x32_bf16 v[140:143], v[72:75], v[104:107], v[140:143]
    ds_read_b64_tr_b16 v[94:95], v35 offset:9216
    v_mfma_f32_16x16x32_bf16 v[144:147], v[72:75], v[108:111], v[144:147]
    ds_read_b64_tr_b16 v[96:97], v36 offset:8192
    v_mfma_f32_16x16x32_bf16 v[148:151], v[76:79], v[100:103], v[148:151]
    ds_read_b64_tr_b16 v[98:99], v36 offset:9216
    v_mfma_f32_16x16x32_bf16 v[152:155], v[76:79], v[104:107], v[152:155]
    v_mfma_f32_16x16x32_bf16 v[156:159], v[76:79], v[108:111], v[156:159]
    v_mfma_f32_16x16x32_bf16 v[160:163], v[80:83], v[100:103], v[160:163]
    v_mfma_f32_16x16x32_bf16 v[164:167], v[80:83], v[104:107], v[164:167]
    v_mfma_f32_16x16x32_bf16 v[168:171], v[80:83], v[108:111], v[168:171]
    s_waitcnt vmcnt(14) lgkmcnt(0)
    s_barrier
    ds_read_b128 v[100:103], v39 offset:28672
    ds_read_b128 v[104:107], v39 offset:30720
    s_add_u32 s50, s51, 14
    s_and_b32 s50, s50, 15
    s_lshl_b32 s49, s50, 19
    s_lshl_b32 s50, s50, 7
    s_add_u32 m0, s47, 57344
    v_mfma_f32_16x16x32_bf16 v[124:127], v[84:87], v[112:115], v[124:127]
    buffer_load_dwordx4 v10, s[12:15], s49 offen offset:0  lds
    ds_read_b128 v[108:111], v39 offset:32768
    ds_read_b64_tr_b16 v[68:69], v33 offset:28672
    v_mfma_f32_16x16x32_bf16 v[128:131], v[84:87], v[116:119], v[128:131]
    buffer_load_dwordx4 v11, s[12:15], s49 offen offset:1024  lds
    ds_read_b64_tr_b16 v[70:71], v33 offset:29696
    ds_read_b64_tr_b16 v[72:73], v34 offset:28672
    v_mfma_f32_16x16x32_bf16 v[132:135], v[84:87], v[120:123], v[132:135]
    buffer_load_dwordx4 v12, s[12:15], s49 offen offset:2048  lds
    ds_read_b64_tr_b16 v[74:75], v34 offset:29696
    v_mfma_f32_16x16x32_bf16 v[136:139], v[88:91], v[112:115], v[136:139]
    buffer_load_dwordx4 v13, s[12:15], s49 offen offset:3072  lds
    ds_read_b64_tr_b16 v[76:77], v35 offset:28672
    v_mfma_f32_16x16x32_bf16 v[140:143], v[88:91], v[116:119], v[140:143]
    ds_read_b64_tr_b16 v[78:79], v35 offset:29696
    v_mfma_f32_16x16x32_bf16 v[144:147], v[88:91], v[120:123], v[144:147]
    ds_read_b64_tr_b16 v[80:81], v36 offset:28672
    v_mfma_f32_16x16x32_bf16 v[148:151], v[92:95], v[112:115], v[148:151]
    ds_read_b64_tr_b16 v[82:83], v36 offset:29696
    v_mfma_f32_16x16x32_bf16 v[152:155], v[92:95], v[116:119], v[152:155]
    v_mfma_f32_16x16x32_bf16 v[156:159], v[92:95], v[120:123], v[156:159]
    v_mfma_f32_16x16x32_bf16 v[160:163], v[96:99], v[112:115], v[160:163]
    v_mfma_f32_16x16x32_bf16 v[164:167], v[96:99], v[116:119], v[164:167]
    v_mfma_f32_16x16x32_bf16 v[168:171], v[96:99], v[120:123], v[168:171]
    s_waitcnt lgkmcnt(0)
    ds_read_b128 v[112:115], v40 offset:28672
    ds_read_b128 v[116:119], v40 offset:30720
    s_add_u32 m0, s48, 57344
    v_mfma_f32_16x16x32_bf16 v[124:127], v[68:71], v[100:103], v[124:127]
    buffer_load_dwordx4 v14, s[8:11], s50 offen offset:0  lds
    ds_read_b128 v[120:123], v40 offset:32768
    ds_read_b64_tr_b16 v[84:85], v33 offset:36864
    v_mfma_f32_16x16x32_bf16 v[128:131], v[68:71], v[104:107], v[128:131]
    buffer_load_dwordx4 v15, s[8:11], s50 offen offset:1024  lds
    ds_read_b64_tr_b16 v[86:87], v33 offset:37888
    ds_read_b64_tr_b16 v[88:89], v34 offset:36864
    v_mfma_f32_16x16x32_bf16 v[132:135], v[68:71], v[108:111], v[132:135]
    buffer_load_dwordx4 v16, s[8:11], s50 offen offset:2048  lds
    ds_read_b64_tr_b16 v[90:91], v34 offset:37888
    v_mfma_f32_16x16x32_bf16 v[136:139], v[72:75], v[100:103], v[136:139]
    ds_read_b64_tr_b16 v[92:93], v35 offset:36864
    v_mfma_f32_16x16x32_bf16 v[140:143], v[72:75], v[104:107], v[140:143]
    ds_read_b64_tr_b16 v[94:95], v35 offset:37888
    v_mfma_f32_16x16x32_bf16 v[144:147], v[72:75], v[108:111], v[144:147]
    ds_read_b64_tr_b16 v[96:97], v36 offset:36864
    v_mfma_f32_16x16x32_bf16 v[148:151], v[76:79], v[100:103], v[148:151]
    ds_read_b64_tr_b16 v[98:99], v36 offset:37888
    v_mfma_f32_16x16x32_bf16 v[152:155], v[76:79], v[104:107], v[152:155]
    v_mfma_f32_16x16x32_bf16 v[156:159], v[76:79], v[108:111], v[156:159]
    v_mfma_f32_16x16x32_bf16 v[160:163], v[80:83], v[100:103], v[160:163]
    v_mfma_f32_16x16x32_bf16 v[164:167], v[80:83], v[104:107], v[164:167]
    v_mfma_f32_16x16x32_bf16 v[168:171], v[80:83], v[108:111], v[168:171]
    s_waitcnt vmcnt(14) lgkmcnt(0)
    s_barrier
    ds_read_b128 v[100:103], v37 offset:0
    ds_read_b128 v[104:107], v37 offset:2048
    s_add_u32 s50, s51, 15
    s_and_b32 s50, s50, 15
    s_lshl_b32 s49, s50, 19
    s_lshl_b32 s50, s50, 7
    s_add_u32 m0, s47, 86016
    v_mfma_f32_16x16x32_bf16 v[124:127], v[84:87], v[112:115], v[124:127]
    buffer_load_dwordx4 v10, s[12:15], s49 offen offset:0  lds
    ds_read_b128 v[108:111], v37 offset:4096
    ds_read_b64_tr_b16 v[68:69], v29 offset:0
    v_mfma_f32_16x16x32_bf16 v[128:131], v[84:87], v[116:119], v[128:131]
    buffer_load_dwordx4 v11, s[12:15], s49 offen offset:1024  lds
    ds_read_b64_tr_b16 v[70:71], v29 offset:1024
    ds_read_b64_tr_b16 v[72:73], v30 offset:0
    v_mfma_f32_16x16x32_bf16 v[132:135], v[84:87], v[120:123], v[132:135]
    buffer_load_dwordx4 v12, s[12:15], s49 offen offset:2048  lds
    ds_read_b64_tr_b16 v[74:75], v30 offset:1024
    v_mfma_f32_16x16x32_bf16 v[136:139], v[88:91], v[112:115], v[136:139]
    buffer_load_dwordx4 v13, s[12:15], s49 offen offset:3072  lds
    ds_read_b64_tr_b16 v[76:77], v31 offset:0
    v_mfma_f32_16x16x32_bf16 v[140:143], v[88:91], v[116:119], v[140:143]
    ds_read_b64_tr_b16 v[78:79], v31 offset:1024
    v_mfma_f32_16x16x32_bf16 v[144:147], v[88:91], v[120:123], v[144:147]
    ds_read_b64_tr_b16 v[80:81], v32 offset:0
    v_mfma_f32_16x16x32_bf16 v[148:151], v[92:95], v[112:115], v[148:151]
    ds_read_b64_tr_b16 v[82:83], v32 offset:1024
    v_mfma_f32_16x16x32_bf16 v[152:155], v[92:95], v[116:119], v[152:155]
    v_mfma_f32_16x16x32_bf16 v[156:159], v[92:95], v[120:123], v[156:159]
    v_mfma_f32_16x16x32_bf16 v[160:163], v[96:99], v[112:115], v[160:163]
    v_mfma_f32_16x16x32_bf16 v[164:167], v[96:99], v[116:119], v[164:167]
    v_mfma_f32_16x16x32_bf16 v[168:171], v[96:99], v[120:123], v[168:171]
    s_waitcnt lgkmcnt(0)
    ds_read_b128 v[112:115], v38 offset:0
    ds_read_b128 v[116:119], v38 offset:2048
    s_add_u32 m0, s48, 86016
    v_mfma_f32_16x16x32_bf16 v[124:127], v[68:71], v[100:103], v[124:127]
    buffer_load_dwordx4 v14, s[8:11], s50 offen offset:0  lds
    ds_read_b128 v[120:123], v38 offset:4096
    ds_read_b64_tr_b16 v[84:85], v29 offset:8192
    v_mfma_f32_16x16x32_bf16 v[128:131], v[68:71], v[104:107], v[128:131]
    buffer_load_dwordx4 v15, s[8:11], s50 offen offset:1024  lds
    ds_read_b64_tr_b16 v[86:87], v29 offset:9216
    ds_read_b64_tr_b16 v[88:89], v30 offset:8192
    v_mfma_f32_16x16x32_bf16 v[132:135], v[68:71], v[108:111], v[132:135]
    buffer_load_dwordx4 v16, s[8:11], s50 offen offset:2048  lds
    ds_read_b64_tr_b16 v[90:91], v30 offset:9216
    v_mfma_f32_16x16x32_bf16 v[136:139], v[72:75], v[100:103], v[136:139]
    ds_read_b64_tr_b16 v[92:93], v31 offset:8192
    v_mfma_f32_16x16x32_bf16 v[140:143], v[72:75], v[104:107], v[140:143]
    ds_read_b64_tr_b16 v[94:95], v31 offset:9216
    v_mfma_f32_16x16x32_bf16 v[144:147], v[72:75], v[108:111], v[144:147]
    ds_read_b64_tr_b16 v[96:97], v32 offset:8192
    v_mfma_f32_16x16x32_bf16 v[148:151], v[76:79], v[100:103], v[148:151]
    ds_read_b64_tr_b16 v[98:99], v32 offset:9216
    v_mfma_f32_16x16x32_bf16 v[152:155], v[76:79], v[104:107], v[152:155]
    v_mfma_f32_16x16x32_bf16 v[156:159], v[76:79], v[108:111], v[156:159]
    v_mfma_f32_16x16x32_bf16 v[160:163], v[80:83], v[100:103], v[160:163]
    v_mfma_f32_16x16x32_bf16 v[164:167], v[80:83], v[104:107], v[164:167]
    v_mfma_f32_16x16x32_bf16 v[168:171], v[80:83], v[108:111], v[168:171]
    s_waitcnt vmcnt(14) lgkmcnt(0)
    s_barrier
    ds_read_b128 v[100:103], v37 offset:28672
    ds_read_b128 v[104:107], v37 offset:30720
    s_add_u32 m0, s85, 114688
    s_nop 0
    buffer_load_dwordx4 v17, s[16:19], 0 offen offset:0 nt lds
    v_mfma_f32_16x16x32_bf16 v[124:127], v[84:87], v[112:115], v[124:127]
    buffer_load_dwordx4 v18, s[16:19], 0 offen offset:1024 nt lds
    ds_read_b128 v[108:111], v37 offset:32768
    ds_read_b64_tr_b16 v[68:69], v29 offset:28672
    v_lshrrev_b32 v6, 2, v1
    v_mfma_f32_16x16x32_bf16 v[128:131], v[84:87], v[116:119], v[128:131]
    buffer_load_dwordx4 v19, s[16:19], 0 offen offset:2048 nt lds
    ds_read_b64_tr_b16 v[70:71], v29 offset:29696
    ds_read_b64_tr_b16 v[72:73], v30 offset:28672
    v_lshlrev_b32 v6, 11, v6
    v_lshl_add_u32 v6, v5, 4, v6
    v_mfma_f32_16x16x32_bf16 v[132:135], v[84:87], v[120:123], v[132:135]
    ds_read_b64_tr_b16 v[74:75], v30 offset:29696
    s_xor_b32 s55, s42, 1
    s_lshl_b32 s55, s55, 8
    v_mfma_f32_16x16x32_bf16 v[136:139], v[88:91], v[112:115], v[136:139]
    ds_read_b64_tr_b16 v[76:77], v31 offset:28672
    s_lshl_b32 s56, s44, 6
    s_add_u32 s55, s55, s56
    v_mfma_f32_16x16x32_bf16 v[140:143], v[88:91], v[116:119], v[140:143]
    ds_read_b64_tr_b16 v[78:79], v31 offset:29696
    v_add_u32 v10, s55, v6
    v_add_u32 v11, 31744, v10
    v_mfma_f32_16x16x32_bf16 v[144:147], v[88:91], v[120:123], v[144:147]
    ds_read_b64_tr_b16 v[80:81], v32 offset:28672
    v_add_u32 v12, 63488, v10
    v_mfma_f32_16x16x32_bf16 v[148:151], v[92:95], v[112:115], v[148:151]
    ds_read_b64_tr_b16 v[82:83], v32 offset:29696
    v_add_u32 v13, 95232, v10
    v_mfma_f32_16x16x32_bf16 v[152:155], v[92:95], v[116:119], v[152:155]
    v_add_u32 v14, 131072, v10
    v_mfma_f32_16x16x32_bf16 v[156:159], v[92:95], v[120:123], v[156:159]
    v_add_u32 v15, 162816, v10
    v_mfma_f32_16x16x32_bf16 v[160:163], v[96:99], v[112:115], v[160:163]
    v_add_u32 v16, 194560, v10
    v_mfma_f32_16x16x32_bf16 v[164:167], v[96:99], v[116:119], v[164:167]
    v_add_u32 v56, 226304, v10
    v_mfma_f32_16x16x32_bf16 v[168:171], v[96:99], v[120:123], v[168:171]
    s_waitcnt lgkmcnt(0)
    ds_read_b128 v[112:115], v38 offset:28672
    ds_read_b128 v[116:119], v38 offset:30720
    v_mfma_f32_16x16x32_bf16 v[124:127], v[68:71], v[100:103], v[124:127]
    buffer_load_dwordx4 v20, s[16:19], 0 offen offset:3072 nt lds
    ds_read_b128 v[120:123], v38 offset:32768
    ds_read_b64_tr_b16 v[84:85], v29 offset:36864
    s_add_u32 m0, s85, 118784
    v_mfma_f32_16x16x32_bf16 v[128:131], v[68:71], v[104:107], v[128:131]
    buffer_load_dwordx4 v21, s[16:19], 0 offen offset:0 nt lds
    ds_read_b64_tr_b16 v[86:87], v29 offset:37888
    ds_read_b64_tr_b16 v[88:89], v30 offset:36864
    v_mfma_f32_16x16x32_bf16 v[132:135], v[68:71], v[108:111], v[132:135]
    buffer_load_dwordx4 v22, s[16:19], 0 offen offset:1024 nt lds
    ds_read_b64_tr_b16 v[90:91], v30 offset:37888
    v_mfma_f32_16x16x32_bf16 v[136:139], v[72:75], v[100:103], v[136:139]
    ds_read_b64_tr_b16 v[92:93], v31 offset:36864
    v_mfma_f32_16x16x32_bf16 v[140:143], v[72:75], v[104:107], v[140:143]
    ds_read_b64_tr_b16 v[94:95], v31 offset:37888
    v_mfma_f32_16x16x32_bf16 v[144:147], v[72:75], v[108:111], v[144:147]
    ds_read_b64_tr_b16 v[96:97], v32 offset:36864
    v_mfma_f32_16x16x32_bf16 v[148:151], v[76:79], v[100:103], v[148:151]
    ds_read_b64_tr_b16 v[98:99], v32 offset:37888
    v_mfma_f32_16x16x32_bf16 v[152:155], v[76:79], v[104:107], v[152:155]
    v_mfma_f32_16x16x32_bf16 v[156:159], v[76:79], v[108:111], v[156:159]
    v_mfma_f32_16x16x32_bf16 v[160:163], v[80:83], v[100:103], v[160:163]
    v_mfma_f32_16x16x32_bf16 v[164:167], v[80:83], v[104:107], v[164:167]
    v_mfma_f32_16x16x32_bf16 v[168:171], v[80:83], v[108:111], v[168:171]
    s_waitcnt vmcnt(13) lgkmcnt(0)
    s_barrier
    buffer_load_dword v54, v65, s[36:39], 0 offen sc1
    ds_read_b128 v[100:103], v39 offset:0
    ds_read_b128 v[104:107], v39 offset:2048
    v_mfma_f32_16x16x32_bf16 v[124:127], v[84:87], v[112:115], v[124:127]
    ds_read_b128 v[108:111], v39 offset:4096
    ds_read_b64_tr_b16 v[68:69], v33 offset:0
    v_mfma_f32_16x16x32_bf16 v[128:131], v[84:87], v[116:119], v[128:131]
    ds_read_b64_tr_b16 v[70:71], v33 offset:1024
    ds_read_b64_tr_b16 v[72:73], v34 offset:0
    v_mfma_f32_16x16x32_bf16 v[132:135], v[84:87], v[120:123], v[132:135]
    ds_read_b64_tr_b16 v[74:75], v34 offset:1024
    v_mfma_f32_16x16x32_bf16 v[136:139], v[88:91], v[112:115], v[136:139]
    ds_read_b64_tr_b16 v[76:77], v35 offset:0
    v_mfma_f32_16x16x32_bf16 v[140:143], v[88:91], v[116:119], v[140:143]
    ds_read_b64_tr_b16 v[78:79], v35 offset:1024
    v_mfma_f32_16x16x32_bf16 v[144:147], v[88:91], v[120:123], v[144:147]
    ds_read_b64_tr_b16 v[80:81], v36 offset:0
    v_mfma_f32_16x16x32_bf16 v[148:151], v[92:95], v[112:115], v[148:151]
    ds_read_b64_tr_b16 v[82:83], v36 offset:1024
    v_mfma_f32_16x16x32_bf16 v[152:155], v[92:95], v[116:119], v[152:155]
    v_mfma_f32_16x16x32_bf16 v[156:159], v[92:95], v[120:123], v[156:159]
    v_mfma_f32_16x16x32_bf16 v[160:163], v[96:99], v[112:115], v[160:163]
    v_mfma_f32_16x16x32_bf16 v[164:167], v[96:99], v[116:119], v[164:167]
    v_mfma_f32_16x16x32_bf16 v[168:171], v[96:99], v[120:123], v[168:171]
    s_waitcnt lgkmcnt(0)
    ds_read_b128 v[112:115], v40 offset:0
    ds_read_b128 v[116:119], v40 offset:2048
    s_add_u32 m0, s85, 139264
    v_mfma_f32_16x16x32_bf16 v[124:127], v[68:71], v[100:103], v[124:127]
    buffer_load_dwordx4 v23, s[20:23], 0 offen offset:0 nt lds
    ds_read_b128 v[120:123], v40 offset:4096
    ds_read_b64_tr_b16 v[84:85], v33 offset:8192
    v_mfma_f32_16x16x32_bf16 v[128:131], v[68:71], v[104:107], v[128:131]
    buffer_load_dwordx4 v24, s[20:23], 0 offen offset:1024 nt lds
    ds_read_b64_tr_b16 v[86:87], v33 offset:9216
    ds_read_b64_tr_b16 v[88:89], v34 offset:8192
    v_mfma_f32_16x16x32_bf16 v[132:135], v[68:71], v[108:111], v[132:135]
    ds_read_b64_tr_b16 v[90:91], v34 offset:9216
    v_mfma_f32_16x16x32_bf16 v[136:139], v[72:75], v[100:103], v[136:139]
    ds_read_b64_tr_b16 v[92:93], v35 offset:8192
    v_mfma_f32_16x16x32_bf16 v[140:143], v[72:75], v[104:107], v[140:143]
    ds_read_b64_tr_b16 v[94:95], v35 offset:9216
    v_mfma_f32_16x16x32_bf16 v[144:147], v[72:75], v[108:111], v[144:147]
    ds_read_b64_tr_b16 v[96:97], v36 offset:8192
    v_mfma_f32_16x16x32_bf16 v[148:151], v[76:79], v[100:103], v[148:151]
    ds_read_b64_tr_b16 v[98:99], v36 offset:9216
    v_mfma_f32_16x16x32_bf16 v[152:155], v[76:79], v[104:107], v[152:155]
    v_mfma_f32_16x16x32_bf16 v[156:159], v[76:79], v[108:111], v[156:159]
    v_mfma_f32_16x16x32_bf16 v[160:163], v[80:83], v[100:103], v[160:163]
    v_mfma_f32_16x16x32_bf16 v[164:167], v[80:83], v[104:107], v[164:167]
    v_mfma_f32_16x16x32_bf16 v[168:171], v[80:83], v[108:111], v[168:171]
    s_waitcnt vmcnt(9) lgkmcnt(0)
    s_barrier
    ds_read_b128 v[100:103], v39 offset:28672
    ds_read_b128 v[104:107], v39 offset:30720
    v_mfma_f32_16x16x32_bf16 v[124:127], v[84:87], v[112:115], v[124:127]
    buffer_load_dwordx4 v25, s[20:23], 0 offen offset:2048 nt lds
    ds_read_b128 v[108:111], v39 offset:32768
    ds_read_b64_tr_b16 v[68:69], v33 offset:28672
    v_mfma_f32_16x16x32_bf16 v[128:131], v[84:87], v[116:119], v[128:131]
    buffer_load_dwordx4 v26, s[20:23], 0 offen offset:3072 nt lds
    ds_read_b64_tr_b16 v[70:71], v33 offset:29696
    ds_read_b64_tr_b16 v[72:73], v34 offset:28672
    v_mfma_f32_16x16x32_bf16 v[132:135], v[84:87], v[120:123], v[132:135]
    ds_read_b64_tr_b16 v[74:75], v34 offset:29696
    v_mfma_f32_16x16x32_bf16 v[136:139], v[88:91], v[112:115], v[136:139]
    ds_read_b64_tr_b16 v[76:77], v35 offset:28672
    v_mfma_f32_16x16x32_bf16 v[140:143], v[88:91], v[116:119], v[140:143]
    ds_read_b64_tr_b16 v[78:79], v35 offset:29696
    v_mfma_f32_16x16x32_bf16 v[144:147], v[88:91], v[120:123], v[144:147]
    ds_read_b64_tr_b16 v[80:81], v36 offset:28672
    v_mfma_f32_16x16x32_bf16 v[148:151], v[92:95], v[112:115], v[148:151]
    ds_read_b64_tr_b16 v[82:83], v36 offset:29696
    v_mfma_f32_16x16x32_bf16 v[152:155], v[92:95], v[116:119], v[152:155]
    v_mfma_f32_16x16x32_bf16 v[156:159], v[92:95], v[120:123], v[156:159]
    v_mfma_f32_16x16x32_bf16 v[160:163], v[96:99], v[112:115], v[160:163]
    v_mfma_f32_16x16x32_bf16 v[164:167], v[96:99], v[116:119], v[164:167]
    v_mfma_f32_16x16x32_bf16 v[168:171], v[96:99], v[120:123], v[168:171]
    s_waitcnt lgkmcnt(0)
    ds_read_b128 v[112:115], v40 offset:28672
    ds_read_b128 v[116:119], v40 offset:30720
    s_add_u32 m0, s85, 143360
    v_mfma_f32_16x16x32_bf16 v[124:127], v[68:71], v[100:103], v[124:127]
    buffer_load_dwordx4 v27, s[20:23], 0 offen offset:0 nt lds
    ds_read_b128 v[120:123], v40 offset:32768
    ds_read_b64_tr_b16 v[84:85], v33 offset:36864
    v_mfma_f32_16x16x32_bf16 v[128:131], v[68:71], v[104:107], v[128:131]
    buffer_load_dwordx4 v28, s[20:23], 0 offen offset:1024 nt lds
    ds_read_b64_tr_b16 v[86:87], v33 offset:37888
    ds_read_b64_tr_b16 v[88:89], v34 offset:36864
    v_mfma_f32_16x16x32_bf16 v[132:135], v[68:71], v[108:111], v[132:135]
    ds_read_b64_tr_b16 v[90:91], v34 offset:37888
    v_mfma_f32_16x16x32_bf16 v[136:139], v[72:75], v[100:103], v[136:139]
    ds_read_b64_tr_b16 v[92:93], v35 offset:36864
    v_mfma_f32_16x16x32_bf16 v[140:143], v[72:75], v[104:107], v[140:143]
    ds_read_b64_tr_b16 v[94:95], v35 offset:37888
    v_mfma_f32_16x16x32_bf16 v[144:147], v[72:75], v[108:111], v[144:147]
    ds_read_b64_tr_b16 v[96:97], v36 offset:36864
    v_mfma_f32_16x16x32_bf16 v[148:151], v[76:79], v[100:103], v[148:151]
    ds_read_b64_tr_b16 v[98:99], v36 offset:37888
    v_mfma_f32_16x16x32_bf16 v[152:155], v[76:79], v[104:107], v[152:155]
    v_mfma_f32_16x16x32_bf16 v[156:159], v[76:79], v[108:111], v[156:159]
    v_mfma_f32_16x16x32_bf16 v[160:163], v[80:83], v[100:103], v[160:163]
    v_mfma_f32_16x16x32_bf16 v[164:167], v[80:83], v[104:107], v[164:167]
    v_mfma_f32_16x16x32_bf16 v[168:171], v[80:83], v[108:111], v[168:171]
    s_waitcnt lgkmcnt(0)
    s_barrier
    v_mfma_f32_16x16x32_bf16 v[124:127], v[84:87], v[112:115], v[124:127]
    v_mfma_f32_16x16x32_bf16 v[128:131], v[84:87], v[116:119], v[128:131]
    v_mfma_f32_16x16x32_bf16 v[132:135], v[84:87], v[120:123], v[132:135]
    v_mfma_f32_16x16x32_bf16 v[136:139], v[88:91], v[112:115], v[136:139]
    v_mfma_f32_16x16x32_bf16 v[140:143], v[88:91], v[116:119], v[140:143]
    v_mfma_f32_16x16x32_bf16 v[144:147], v[88:91], v[120:123], v[144:147]
    v_mfma_f32_16x16x32_bf16 v[148:151], v[92:95], v[112:115], v[148:151]
    v_mfma_f32_16x16x32_bf16 v[152:155], v[92:95], v[116:119], v[152:155]
    v_mfma_f32_16x16x32_bf16 v[156:159], v[92:95], v[120:123], v[156:159]
    v_mfma_f32_16x16x32_bf16 v[160:163], v[96:99], v[112:115], v[160:163]
    v_mfma_f32_16x16x32_bf16 v[164:167], v[96:99], v[116:119], v[164:167]
    v_mfma_f32_16x16x32_bf16 v[168:171], v[96:99], v[120:123], v[168:171]
    s_waitcnt vmcnt(7)
    s_barrier
    ds_read_b64 v[172:173], v41 offset:0
    ds_read_b64 v[174:175], v42 offset:0
    ds_read_b64 v[176:177], v43 offset:0
    ds_read_b64 v[178:179], v44 offset:0
    ds_read_b64 v[180:181], v41 offset:4096
    ds_read_b64 v[182:183], v42 offset:4096
    ds_read_b64 v[184:185], v43 offset:4096
    ds_read_b64 v[186:187], v44 offset:4096
    ds_read_b64 v[188:189], v41 offset:8192
    ds_read_b64 v[190:191], v42 offset:8192
    ds_read_b64 v[192:193], v43 offset:8192
    ds_read_b64 v[194:195], v44 offset:8192
    s_add_u32 m0, s47, 0
    s_nop 0
    buffer_load_dwordx4 v10, s[28:31], s60 offen offset:0  lds
    buffer_load_dwordx4 v11, s[28:31], s60 offen offset:1024  lds
    buffer_load_dwordx4 v12, s[28:31], s60 offen offset:2048  lds
    buffer_load_dwordx4 v13, s[28:31], s60 offen offset:3072  lds
    v_cvt_pk_bf16_f32 v196, v124, v125
    v_cvt_pk_bf16_f32 v197, v126, v127
    v_cvt_pk_bf16_f32 v198, v136, v137
    v_cvt_pk_bf16_f32 v199, v138, v139
    v_cvt_pk_bf16_f32 v200, v128, v129
    v_cvt_pk_bf16_f32 v201, v130, v131
    v_cvt_pk_bf16_f32 v202, v140, v141
    v_cvt_pk_bf16_f32 v203, v142, v143
    v_cvt_pk_bf16_f32 v204, v132, v133
    v_cvt_pk_bf16_f32 v205, v134, v135
    v_cvt_pk_bf16_f32 v206, v144, v145
    v_cvt_pk_bf16_f32 v207, v146, v147
    v_cvt_pk_bf16_f32 v208, v148, v149
    v_cvt_pk_bf16_f32 v209, v150, v151
    v_cvt_pk_bf16_f32 v210, v160, v161
    v_cvt_pk_bf16_f32 v211, v162, v163
    v_cvt_pk_bf16_f32 v212, v152, v153
    v_cvt_pk_bf16_f32 v213, v154, v155
    v_cvt_pk_bf16_f32 v214, v164, v165
    v_cvt_pk_bf16_f32 v215, v166, v167
    v_cvt_pk_bf16_f32 v216, v156, v157
    v_cvt_pk_bf16_f32 v217, v158, v159
    v_cvt_pk_bf16_f32 v218, v168, v169
    v_cvt_pk_bf16_f32 v219, v170, v171
    s_waitcnt lgkmcnt(0)
    s_nop 0
    v_mfma_f32_16x16x32_bf16 v[220:223], v[172:175], v[196:199], 0
    s_add_u32 m0, s47, 16384
    s_nop 0
    buffer_load_dwordx4 v14, s[28:31], s60 offen offset:0  lds
    buffer_load_dwordx4 v15, s[28:31], s60 offen offset:1024  lds
    buffer_load_dwordx4 v16, s[28:31], s60 offen offset:2048  lds
    v_mfma_f32_16x16x32_bf16 v[224:227], v[180:183], v[196:199], 0
    buffer_load_dwordx4 v56, s[28:31], s60 offen offset:3072  lds
    s_mul_i32 s57, s44, 3072
    s_add_u32 s58, s57, s68
    v_mfma_f32_16x16x32_bf16 v[228:231], v[188:191], v[196:199], 0
    v_add_u32 v17, s58, v53
    s_add_u32 s58, s68, 114688
    v_add_u32 v23, s58, v53
    v_mfma_f32_16x16x32_bf16 v[232:235], v[172:175], v[200:203], 0
    s_add_u32 s58, s57, s69
    v_add_u32 v18, s58, v53
    s_add_u32 s58, s69, 114688
    v_mfma_f32_16x16x32_bf16 v[236:239], v[180:183], v[200:203], 0
    v_add_u32 v24, s58, v53
    s_add_u32 s58, s57, s70
    v_add_u32 v19, s58, v53
    v_mfma_f32_16x16x32_bf16 v[240:243], v[188:191], v[200:203], 0
    s_add_u32 s58, s70, 114688
    v_add_u32 v25, s58, v53
    s_add_u32 s58, s57, s71
    v_mfma_f32_16x16x32_bf16 v[244:247], v[172:175], v[204:207], 0
    v_add_u32 v20, s58, v53
    s_add_u32 s58, s71, 114688
    v_add_u32 v26, s58, v53
    v_mfma_f32_16x16x32_bf16 v[248:251], v[180:183], v[204:207], 0
    s_add_u32 s58, s57, s72
    v_add_u32 v21, s58, v53
    s_add_u32 s58, s72, 114688
    v_mfma_f32_16x16x32_bf16 v[252:255], v[188:191], v[204:207], 0
    v_add_u32 v27, s58, v53
    s_add_u32 s58, s57, s73
    v_add_u32 v22, s58, v53
    v_mfma_f32_16x16x32_bf16 v[220:223], v[176:179], v[208:211], v[220:223]
    s_add_u32 s58, s73, 114688
    v_add_u32 v28, s58, v53
    s_bfe_u32 s8, s61, 0x30012
    v_mfma_f32_16x16x32_bf16 v[224:227], v[184:187], v[208:211], v[224:227]
    s_add_u32 s8, s8, s3
    s_mul_i32 s8, s8, 24576
    s_bfe_u32 s9, s62, 0x30012
    v_mfma_f32_16x16x32_bf16 v[228:231], v[192:195], v[208:211], v[228:231]
    s_add_u32 s9, s9, s3
    s_mul_i32 s9, s9, 24576
    s_bfe_u32 s10, s63, 0x30012
    v_mfma_f32_16x16x32_bf16 v[232:235], v[176:179], v[212:215], v[232:235]
    s_add_u32 s10, s10, s3
    s_mul_i32 s10, s10, 24576
    s_bfe_u32 s11, s64, 0x30012
    v_mfma_f32_16x16x32_bf16 v[236:239], v[184:187], v[212:215], v[236:239]
    s_add_u32 s11, s11, s3
    s_mul_i32 s11, s11, 24576
    s_bfe_u32 s12, s65, 0x30012
    v_mfma_f32_16x16x32_bf16 v[240:243], v[192:195], v[212:215], v[240:243]
    s_add_u32 s12, s12, s3
    s_mul_i32 s12, s12, 24576
    v_mfma_f32_16x16x32_bf16 v[244:247], v[176:179], v[216:219], v[244:247]
    s_bfe_u32 s13, s66, 0x30012
    s_add_u32 s13, s13, s3
    v_mfma_f32_16x16x32_bf16 v[248:251], v[184:187], v[216:219], v[248:251]
    s_mul_i32 s13, s13, 24576
    s_bfe_u32 s14, s67, 0x30012
    v_mfma_f32_16x16x32_bf16 v[252:255], v[192:195], v[216:219], v[252:255]
    s_add_u32 s14, s14, s3
    s_mul_i32 s14, s14, 24576
    s_nop 7
    ds_write_b128 v49, v[220:223] offset:0
    ds_write_b128 v49, v[224:227] offset:1024
    ds_write_b128 v49, v[228:231] offset:2048
    ds_write_b128 v49, v[232:235] offset:3072
    ds_write_b128 v49, v[236:239] offset:4096
    ds_write_b128 v49, v[240:243] offset:5120
    ds_write_b128 v49, v[244:247] offset:6144
    ds_write_b128 v49, v[248:251] offset:7168
    ds_write_b128 v49, v[252:255] offset:8192
    s_add_u32 m0, s47, 32768
    s_nop 0
    buffer_load_dwordx4 v10, s[28:31], s61 offen offset:0  lds
    buffer_load_dwordx4 v11, s[28:31], s61 offen offset:1024  lds
    buffer_load_dwordx4 v12, s[28:31], s61 offen offset:2048  lds
    buffer_load_dwordx4 v13, s[28:31], s61 offen offset:3072  lds
    s_waitcnt vmcnt(12) lgkmcnt(0)
    s_barrier
    ds_read_b128 v[68:71], v50 offset:0
    ds_read_b128 v[72:75], v50 offset:1024
    ds_read_b128 v[76:79], v50 offset:2048
    ds_read_b128 v[80:83], v50 offset:3072
    ds_read_b128 v[84:87], v50 offset:4096
    ds_read_b128 v[88:91], v50 offset:5120
    ds_read_b128 v[92:95], v50 offset:6144
    ds_read_b128 v[96:99], v50 offset:7168
    ds_read_b128 v[100:103], v50 offset:8192
    ds_read_b64_tr_b16 v[172:173], v45 offset:0
    ds_read_b64_tr_b16 v[174:175], v45 offset:4096
    ds_read_b64_tr_b16 v[176:177], v45 offset:8192
    ds_read_b64_tr_b16 v[178:179], v46 offset:0
    ds_read_b64_tr_b16 v[180:181], v46 offset:4096
    ds_read_b64_tr_b16 v[182:183], v46 offset:8192
    s_waitcnt lgkmcnt(6)
    ds_read_b64_tr_b16 v[184:185], v47 offset:0
    ds_read_b64_tr_b16 v[186:187], v47 offset:4096
    ds_read_b64_tr_b16 v[188:189], v47 offset:8192
    ds_read_b64_tr_b16 v[190:191], v48 offset:0
    ds_read_b64_tr_b16 v[192:193], v48 offset:4096
    ds_read_b64_tr_b16 v[194:195], v48 offset:8192
    s_waitcnt vmcnt(8)
    ds_read_b64_tr_b16 a[0:1], v52 offset:0
    ds_read_b64_tr_b16 a[4:5], v52 offset:8
    ds_read_b64_tr_b16 a[2:3], v52 offset:1024
    ds_read_b64_tr_b16 a[6:7], v52 offset:1032
    ds_read_b64_tr_b16 a[8:9], v52 offset:2048
    ds_read_b64_tr_b16 a[12:13], v52 offset:2056
    ds_read_b64_tr_b16 a[10:11], v52 offset:3072
    ds_read_b64_tr_b16 a[14:15], v52 offset:3080
    s_add_u32 m0, s47, 49152
    s_nop 0
    buffer_load_dwordx4 v14, s[28:31], s61 offen offset:0  lds
    buffer_load_dwordx4 v15, s[28:31], s61 offen offset:1024  lds
    buffer_load_dwordx4 v16, s[28:31], s61 offen offset:2048  lds
    buffer_load_dwordx4 v56, s[28:31], s61 offen offset:3072  lds
    v_add_f32 v220, v220, v68
    v_add_f32 v221, v221, v69
    v_add_f32 v222, v222, v70
    v_add_f32 v223, v223, v71
    v_add_f32 v224, v224, v72
    v_add_f32 v225, v225, v73
    v_add_f32 v226, v226, v74
    v_add_f32 v227, v227, v75
    v_add_f32 v228, v228, v76
    v_add_f32 v229, v229, v77
    v_add_f32 v230, v230, v78
    v_add_f32 v231, v231, v79
    v_add_f32 v232, v232, v80
    v_add_f32 v233, v233, v81
    v_add_f32 v234, v234, v82
    v_add_f32 v235, v235, v83
    v_add_f32 v236, v236, v84
    v_add_f32 v237, v237, v85
    v_add_f32 v238, v238, v86
    v_add_f32 v239, v239, v87
    v_add_f32 v240, v240, v88
    v_add_f32 v241, v241, v89
    v_add_f32 v242, v242, v90
    v_add_f32 v243, v243, v91
    v_add_f32 v244, v244, v92
    v_add_f32 v245, v245, v93
    v_add_f32 v246, v246, v94
    v_add_f32 v247, v247, v95
    v_add_f32 v248, v248, v96
    v_add_f32 v249, v249, v97
    v_add_f32 v250, v250, v98
    v_add_f32 v251, v251, v99
    v_add_f32 v252, v252, v100
    v_add_f32 v253, v253, v101
    v_add_f32 v254, v254, v102
    v_add_f32 v255, v255, v103
    s_waitcnt vmcnt(8)
    ds_read_b64_tr_b16 a[16:17], v52 offset:16384
    ds_read_b64_tr_b16 a[20:21], v52 offset:16392
    ds_read_b64_tr_b16 a[18:19], v52 offset:17408
    ds_read_b64_tr_b16 a[22:23], v52 offset:17416
    ds_read_b64_tr_b16 a[24:25], v52 offset:18432
    ds_read_b64_tr_b16 a[28:29], v52 offset:18440
    ds_read_b64_tr_b16 a[26:27], v52 offset:19456
    ds_read_b64_tr_b16 a[30:31], v52 offset:19464
    s_waitcnt lgkmcnt(8)
    s_add_u32 m0, s47, 0
    s_nop 0
    buffer_load_dwordx4 v10, s[28:31], s62 offen offset:0  lds
    buffer_load_dwordx4 v11, s[28:31], s62 offen offset:1024  lds
    buffer_load_dwordx4 v12, s[28:31], s62 offen offset:2048  lds
    buffer_load_dwordx4 v13, s[28:31], s62 offen offset:3072  lds
    v_max3_f32 v2, v220, v221, v222
    v_max3_f32 v3, v232, v233, v234
    v_max3_f32 v4, v244, v245, v246
    v_max3_f32 v2, v2, v223, v224
    v_max3_f32 v3, v3, v235, v236
    v_max3_f32 v4, v4, v247, v248
    v_max3_f32 v2, v2, v225, v226
    v_max3_f32 v3, v3, v237, v238
    v_max3_f32 v4, v4, v249, v250
    v_max3_f32 v2, v2, v227, v228
    v_max3_f32 v3, v3, v239, v240
    v_max3_f32 v4, v4, v251, v252
    v_max3_f32 v2, v2, v229, v230
    v_max3_f32 v3, v3, v241, v242
    v_max3_f32 v4, v4, v253, v254
    v_max_f32 v2, v2, v231
    v_max_f32 v3, v3, v243
    v_max_f32 v4, v4, v255
    v_mov_b32 v5, v2
    v_mov_b32 v6, v3
    v_mov_b32 v7, v4
    s_nop 0
    v_permlane16_swap_b32 v2, v5
    v_permlane16_swap_b32 v3, v6
    v_permlane16_swap_b32 v4, v7
    v_max_f32 v2, v2, v5
    v_max_f32 v3, v3, v6
    v_max_f32 v4, v4, v7
    v_mov_b32 v5, v2
    v_mov_b32 v6, v3
    v_mov_b32 v7, v4
    s_nop 0
    v_permlane32_swap_b32 v2, v5
    v_permlane32_swap_b32 v3, v6
    v_permlane32_swap_b32 v4, v7
    v_max_f32 v2, v2, v5
    v_max_f32 v3, v3, v6
    v_max_f32 v4, v4, v7
    s_waitcnt vmcnt(8)
    ds_read_b64_tr_b16 a[32:33], v52 offset:32768
    ds_read_b64_tr_b16 a[36:37], v52 offset:32776
    ds_read_b64_tr_b16 a[34:35], v52 offset:33792
    ds_read_b64_tr_b16 a[38:39], v52 offset:33800
    ds_read_b64_tr_b16 a[40:41], v52 offset:34816
    ds_read_b64_tr_b16 a[44:45], v52 offset:34824
    ds_read_b64_tr_b16 a[42:43], v52 offset:35840
    ds_read_b64_tr_b16 a[46:47], v52 offset:35848
    s_waitcnt lgkmcnt(8)
    s_add_u32 m0, s47, 16384
    s_nop 0
    buffer_load_dwordx4 v14, s[28:31], s62 offen offset:0  lds
    buffer_load_dwordx4 v15, s[28:31], s62 offen offset:1024  lds
    buffer_load_dwordx4 v16, s[28:31], s62 offen offset:2048  lds
    buffer_load_dwordx4 v56, s[28:31], s62 offen offset:3072  lds
    v_mul_f32 v2, s52, v2
    v_mul_f32 v3, s52, v3
    v_mul_f32 v4, s52, v4
    v_fma_f32 v220, v220, s52, -v2
    v_fma_f32 v232, v232, s52, -v3
    v_fma_f32 v244, v244, s52, -v4
    v_fma_f32 v221, v221, s52, -v2
    v_fma_f32 v233, v233, s52, -v3
    v_fma_f32 v245, v245, s52, -v4
    v_fma_f32 v222, v222, s52, -v2
    v_fma_f32 v234, v234, s52, -v3
    v_fma_f32 v246, v246, s52, -v4
    v_fma_f32 v223, v223, s52, -v2
    v_fma_f32 v235, v235, s52, -v3
    v_fma_f32 v247, v247, s52, -v4
    v_fma_f32 v224, v224, s52, -v2
    v_fma_f32 v236, v236, s52, -v3
    v_fma_f32 v248, v248, s52, -v4
    v_fma_f32 v225, v225, s52, -v2
    v_fma_f32 v237, v237, s52, -v3
    v_fma_f32 v249, v249, s52, -v4
    v_fma_f32 v226, v226, s52, -v2
    v_fma_f32 v238, v238, s52, -v3
    v_fma_f32 v250, v250, s52, -v4
    v_fma_f32 v227, v227, s52, -v2
    v_fma_f32 v239, v239, s52, -v3
    v_fma_f32 v251, v251, s52, -v4
    v_fma_f32 v228, v228, s52, -v2
    v_fma_f32 v240, v240, s52, -v3
    v_fma_f32 v252, v252, s52, -v4
    v_fma_f32 v229, v229, s52, -v2
    v_fma_f32 v241, v241, s52, -v3
    v_fma_f32 v253, v253, s52, -v4
    v_fma_f32 v230, v230, s52, -v2
    v_fma_f32 v242, v242, s52, -v3
    v_fma_f32 v254, v254, s52, -v4
    v_fma_f32 v231, v231, s52, -v2
    v_fma_f32 v243, v243, s52, -v3
    v_fma_f32 v255, v255, s52, -v4
    v_exp_f32 v220, v220
    v_exp_f32 v232, v232
    v_exp_f32 v244, v244
    v_exp_f32 v221, v221
    v_exp_f32 v233, v233
    v_exp_f32 v245, v245
    v_exp_f32 v222, v222
    v_exp_f32 v234, v234
    v_exp_f32 v246, v246
    v_exp_f32 v223, v223
    v_exp_f32 v235, v235
    v_exp_f32 v247, v247
    v_exp_f32 v224, v224
    v_exp_f32 v236, v236
    v_exp_f32 v248, v248
    v_exp_f32 v225, v225
    v_exp_f32 v237, v237
    v_exp_f32 v249, v249
    v_exp_f32 v226, v226
    v_exp_f32 v238, v238
    v_exp_f32 v250, v250
    v_exp_f32 v227, v227
    v_exp_f32 v239, v239
    v_exp_f32 v251, v251
    v_exp_f32 v228, v228
    v_exp_f32 v240, v240
    v_exp_f32 v252, v252
    v_exp_f32 v229, v229
    v_exp_f32 v241, v241
    v_exp_f32 v253, v253
    v_exp_f32 v230, v230
    v_exp_f32 v242, v242
    v_exp_f32 v254, v254
    v_exp_f32 v231, v231
    v_exp_f32 v243, v243
    v_exp_f32 v255, v255
    s_waitcnt vmcnt(8)
    ds_read_b64_tr_b16 a[48:49], v52 offset:49152
    ds_read_b64_tr_b16 a[52:53], v52 offset:49160
    ds_read_b64_tr_b16 a[50:51], v52 offset:50176
    ds_read_b64_tr_b16 a[54:55], v52 offset:50184
    ds_read_b64_tr_b16 a[56:57], v52 offset:51200
    ds_read_b64_tr_b16 a[60:61], v52 offset:51208
    ds_read_b64_tr_b16 a[58:59], v52 offset:52224
    ds_read_b64_tr_b16 a[62:63], v52 offset:52232
    s_waitcnt lgkmcnt(8)
    s_add_u32 m0, s47, 32768
    s_nop 0
    buffer_load_dwordx4 v10, s[28:31], s63 offen offset:0  lds
    buffer_load_dwordx4 v11, s[28:31], s63 offen offset:1024  lds
    buffer_load_dwordx4 v12, s[28:31], s63 offen offset:2048  lds
    buffer_load_dwordx4 v13, s[28:31], s63 offen offset:3072  lds
    v_add_f32 v2, v220, v221
    v_add_f32 v3, v232, v233
    v_add_f32 v4, v244, v245
    v_add_f32 v2, v2, v222
    v_add_f32 v3, v3, v234
    v_add_f32 v4, v4, v246
    v_add_f32 v2, v2, v223
    v_add_f32 v3, v3, v235
    v_add_f32 v4, v4, v247
    v_add_f32 v2, v2, v224
    v_add_f32 v3, v3, v236
    v_add_f32 v4, v4, v248
    v_add_f32 v2, v2, v225
    v_add_f32 v3, v3, v237
    v_add_f32 v4, v4, v249
    v_add_f32 v2, v2, v226
    v_add_f32 v3, v3, v238
    v_add_f32 v4, v4, v250
    v_add_f32 v2, v2, v227
    v_add_f32 v3, v3, v239
    v_add_f32 v4, v4, v251
    v_add_f32 v2, v2, v228
    v_add_f32 v3, v3, v240
    v_add_f32 v4, v4, v252
    v_add_f32 v2, v2, v229
    v_add_f32 v3, v3, v241
    v_add_f32 v4, v4, v253
    v_add_f32 v2, v2, v230
    v_add_f32 v3, v3, v242
    v_add_f32 v4, v4, v254
    v_add_f32 v2, v2, v231
    v_add_f32 v3, v3, v243
    v_add_f32 v4, v4, v255
    v_mov_b32 v5, v2
    v_mov_b32 v6, v3
    v_mov_b32 v7, v4
    s_nop 0
    v_permlane16_swap_b32 v2, v5
    v_permlane16_swap_b32 v3, v6
    v_permlane16_swap_b32 v4, v7
    v_add_f32 v2, v2, v5
    v_add_f32 v3, v3, v6
    v_add_f32 v4, v4, v7
    v_mov_b32 v5, v2
    v_mov_b32 v6, v3
    v_mov_b32 v7, v4
    s_nop 0
    v_permlane32_swap_b32 v2, v5
    v_permlane32_swap_b32 v3, v6
    v_permlane32_swap_b32 v4, v7
    v_add_f32 v2, v2, v5
    v_add_f32 v3, v3, v6
    v_add_f32 v4, v4, v7
    v_rcp_f32 v2, v2
    v_rcp_f32 v3, v3
    v_rcp_f32 v4, v4
    s_nop 0
    s_waitcnt vmcnt(8)
    ds_read_b64_tr_b16 a[64:65], v52 offset:0
    ds_read_b64_tr_b16 a[68:69], v52 offset:8
    ds_read_b64_tr_b16 a[66:67], v52 offset:1024
    ds_read_b64_tr_b16 a[70:71], v52 offset:1032
    ds_read_b64_tr_b16 a[72:73], v52 offset:2048
    ds_read_b64_tr_b16 a[76:77], v52 offset:2056
    ds_read_b64_tr_b16 a[74:75], v52 offset:3072
    ds_read_b64_tr_b16 a[78:79], v52 offset:3080
    s_waitcnt lgkmcnt(8)
    s_add_u32 m0, s47, 49152
    s_nop 0
    buffer_load_dwordx4 v14, s[28:31], s63 offen offset:0  lds
    buffer_load_dwordx4 v15, s[28:31], s63 offen offset:1024  lds
    buffer_load_dwordx4 v16, s[28:31], s63 offen offset:2048  lds
    buffer_load_dwordx4 v56, s[28:31], s63 offen offset:3072  lds
    v_mul_f32 v220, v220, v2
    v_mul_f32 v232, v232, v3
    v_mul_f32 v244, v244, v4
    v_mul_f32 v221, v221, v2
    v_mul_f32 v233, v233, v3
    v_mul_f32 v245, v245, v4
    v_mul_f32 v222, v222, v2
    v_mul_f32 v234, v234, v3
    v_mul_f32 v246, v246, v4
    v_mul_f32 v223, v223, v2
    v_mul_f32 v235, v235, v3
    v_mul_f32 v247, v247, v4
    v_mul_f32 v224, v224, v2
    v_mul_f32 v236, v236, v3
    v_mul_f32 v248, v248, v4
    v_mul_f32 v225, v225, v2
    v_mul_f32 v237, v237, v3
    v_mul_f32 v249, v249, v4
    v_mul_f32 v226, v226, v2
    v_mul_f32 v238, v238, v3
    v_mul_f32 v250, v250, v4
    v_mul_f32 v227, v227, v2
    v_mul_f32 v239, v239, v3
    v_mul_f32 v251, v251, v4
    v_mul_f32 v228, v228, v2
    v_mul_f32 v240, v240, v3
    v_mul_f32 v252, v252, v4
    v_mul_f32 v229, v229, v2
    v_mul_f32 v241, v241, v3
    v_mul_f32 v253, v253, v4
    v_mul_f32 v230, v230, v2
    v_mul_f32 v242, v242, v3
    v_mul_f32 v254, v254, v4
    v_mul_f32 v231, v231, v2
    v_mul_f32 v243, v243, v3
    v_mul_f32 v255, v255, v4
    v_cvt_pk_bf16_f32 v196, v220, v221
    v_cvt_pk_bf16_f32 v197, v222, v223
    v_cvt_pk_bf16_f32 v198, v224, v225
    v_cvt_pk_bf16_f32 v199, v226, v227
    v_cvt_pk_bf16_f32 v200, v228, v229
    v_cvt_pk_bf16_f32 v201, v230, v231
    v_cvt_pk_bf16_f32 v202, v232, v233
    v_cvt_pk_bf16_f32 v203, v234, v235
    v_cvt_pk_bf16_f32 v204, v236, v237
    v_cvt_pk_bf16_f32 v205, v238, v239
    v_cvt_pk_bf16_f32 v206, v240, v241
    v_cvt_pk_bf16_f32 v207, v242, v243
    v_cvt_pk_bf16_f32 v208, v244, v245
    v_cvt_pk_bf16_f32 v209, v246, v247
    v_cvt_pk_bf16_f32 v210, v248, v249
    v_cvt_pk_bf16_f32 v211, v250, v251
    v_cvt_pk_bf16_f32 v212, v252, v253
    v_cvt_pk_bf16_f32 v213, v254, v255
    s_waitcnt vmcnt(8)
    ds_read_b64_tr_b16 a[80:81], v52 offset:16384
    ds_read_b64_tr_b16 a[84:85], v52 offset:16392
    ds_read_b64_tr_b16 a[82:83], v52 offset:17408
    ds_read_b64_tr_b16 a[86:87], v52 offset:17416
    ds_read_b64_tr_b16 a[88:89], v52 offset:18432
    ds_read_b64_tr_b16 a[92:93], v52 offset:18440
    ds_read_b64_tr_b16 a[90:91], v52 offset:19456
    ds_read_b64_tr_b16 a[94:95], v52 offset:19464
    s_waitcnt lgkmcnt(8)
    s_add_u32 m0, s47, 0
    s_nop 0
    buffer_load_dwordx4 v10, s[28:31], s64 offen offset:0  lds
    buffer_load_dwordx4 v11, s[28:31], s64 offen offset:1024  lds
    buffer_load_dwordx4 v12, s[28:31], s64 offen offset:2048  lds
    buffer_load_dwordx4 v13, s[28:31], s64 offen offset:3072  lds
    s_nop 0
    v_mfma_f32_16x16x32_bf16 v[124:127], v[172:175], v[196:199], 0
    s_waitcnt vmcnt(8)
    v_mfma_f32_16x16x32_bf16 v[128:131], v[172:175], v[202:205], 0
    ds_read_b64_tr_b16 a[96:97], v52 offset:32768
    v_mfma_f32_16x16x32_bf16 v[132:135], v[172:175], v[208:211], 0
    ds_read_b64_tr_b16 a[100:101], v52 offset:32776
    v_mfma_f32_16x16x32_bf16 v[136:139], v[178:181], v[196:199], 0
    ds_read_b64_tr_b16 a[98:99], v52 offset:33792
    v_mfma_f32_16x16x32_bf16 v[140:143], v[178:181], v[202:205], 0
    ds_read_b64_tr_b16 a[102:103], v52 offset:33800
    v_mfma_f32_16x16x32_bf16 v[144:147], v[178:181], v[208:211], 0
    ds_read_b64_tr_b16 a[104:105], v52 offset:34816
    v_mfma_f32_16x16x32_bf16 v[148:151], v[184:187], v[196:199], 0
    ds_read_b64_tr_b16 a[108:109], v52 offset:34824
    v_mfma_f32_16x16x32_bf16 v[152:155], v[184:187], v[202:205], 0
    ds_read_b64_tr_b16 a[106:107], v52 offset:35840
    v_mfma_f32_16x16x32_bf16 v[156:159], v[184:187], v[208:211], 0
    ds_read_b64_tr_b16 a[110:111], v52 offset:35848
    v_mfma_f32_16x16x32_bf16 v[160:163], v[190:193], v[196:199], 0
    s_waitcnt lgkmcnt(8)
    v_mfma_f32_16x16x32_bf16 v[164:167], v[190:193], v[202:205], 0
    s_add_u32 m0, s47, 16384
    s_nop 0
    buffer_load_dwordx4 v14, s[28:31], s64 offen offset:0  lds
    v_mfma_f32_16x16x32_bf16 v[168:171], v[190:193], v[208:211], 0
    buffer_load_dwordx4 v15, s[28:31], s64 offen offset:1024  lds
    v_mfma_f32_16x16x16_bf16 v[124:127], v[176:177], v[200:201], v[124:127]
    buffer_load_dwordx4 v16, s[28:31], s64 offen offset:2048  lds
    v_mfma_f32_16x16x16_bf16 v[128:131], v[176:177], v[206:207], v[128:131]
    buffer_load_dwordx4 v56, s[28:31], s64 offen offset:3072  lds
    v_mfma_f32_16x16x16_bf16 v[132:135], v[176:177], v[212:213], v[132:135]
    v_mfma_f32_16x16x16_bf16 v[136:139], v[182:183], v[200:201], v[136:139]
    v_mfma_f32_16x16x16_bf16 v[140:143], v[182:183], v[206:207], v[140:143]
    v_mfma_f32_16x16x16_bf16 v[144:147], v[182:183], v[212:213], v[144:147]
    v_mfma_f32_16x16x16_bf16 v[148:151], v[188:189], v[200:201], v[148:151]
    v_mfma_f32_16x16x16_bf16 v[152:155], v[188:189], v[206:207], v[152:155]
    v_mfma_f32_16x16x16_bf16 v[156:159], v[188:189], v[212:213], v[156:159]
    v_mfma_f32_16x16x16_bf16 v[160:163], v[194:195], v[200:201], v[160:163]
    v_mfma_f32_16x16x16_bf16 v[164:167], v[194:195], v[206:207], v[164:167]
    v_mfma_f32_16x16x16_bf16 v[168:171], v[194:195], v[212:213], v[168:171]
    s_nop 7
    v_cvt_pk_bf16_f32 v220, v124, v125
    v_cvt_pk_bf16_f32 v221, v126, v127
    v_cvt_pk_bf16_f32 v222, v136, v137
    v_cvt_pk_bf16_f32 v223, v138, v139
    v_cvt_pk_bf16_f32 v224, v128, v129
    v_cvt_pk_bf16_f32 v225, v130, v131
    v_cvt_pk_bf16_f32 v226, v140, v141
    v_cvt_pk_bf16_f32 v227, v142, v143
    v_cvt_pk_bf16_f32 v228, v132, v133
    v_cvt_pk_bf16_f32 v229, v134, v135
    v_cvt_pk_bf16_f32 v230, v144, v145
    v_cvt_pk_bf16_f32 v231, v146, v147
    v_cvt_pk_bf16_f32 v232, v148, v149
    v_cvt_pk_bf16_f32 v233, v150, v151
    v_cvt_pk_bf16_f32 v234, v160, v161
    v_cvt_pk_bf16_f32 v235, v162, v163
    v_cvt_pk_bf16_f32 v236, v152, v153
    v_cvt_pk_bf16_f32 v237, v154, v155
    v_cvt_pk_bf16_f32 v238, v164, v165
    v_cvt_pk_bf16_f32 v239, v166, v167
    v_cvt_pk_bf16_f32 v240, v156, v157
    v_cvt_pk_bf16_f32 v241, v158, v159
    v_cvt_pk_bf16_f32 v242, v168, v169
    v_cvt_pk_bf16_f32 v243, v170, v171
    s_mov_b32 s88, 0
L_dbg_chk:
    v_and_b32 v6, 8, v54
    v_cmp_ne_u32 vcc, 8, v6
    s_add_u32 s88, s88, 1
    s_cbranch_vccz L_dbg_ok
    s_cmp_ge_u32 s88, 200000
    s_cbranch_scc1 L_dbg_ok
    buffer_load_dword v54, v65, s[36:39], 0 offen sc1
    s_waitcnt vmcnt(0)
    s_branch L_dbg_chk
L_dbg_ok:
    v_readlane_b32 s55, v54, s41
    s_bfe_u32 s56, s55, 0x80008
    s_lshr_b32 s57, s55, 16
    s_mul_i32 s56, s56, s56
    s_lshl_b32 s57, s57, 3
    s_cmp_eq_u32 s56, s57
    s_cselect_b32 s54, 1, 0
    s_cmp_eq_u32 s54, 1
    s_cbranch_scc0 L_ost_rem
    s_mov_b32 s55, 4096
    buffer_store_dwordx4 v[220:223], v51, s[24:27], 0 offen offset:0 sc1
    buffer_store_dwordx4 v[224:227], v51, s[24:27], 0 offen offset:1024 sc1
    buffer_store_dwordx4 v[228:231], v51, s[24:27], 0 offen offset:2048 sc1
    buffer_store_dwordx4 v[232:235], v51, s[24:27], 0 offen offset:3072 sc1
    buffer_store_dwordx4 v[236:239], v51, s[24:27], s55 offen offset:0 sc1
    buffer_store_dwordx4 v[240:243], v51, s[24:27], s55 offen offset:1024 sc1
    s_branch L_ost_done
L_ost_rem:
    s_mov_b32 s55, 4096
    buffer_store_dwordx4 v[220:223], v51, s[24:27], 0 offen offset:0 sc1
    buffer_store_dwordx4 v[224:227], v51, s[24:27], 0 offen offset:1024 sc1
    buffer_store_dwordx4 v[228:231], v51, s[24:27], 0 offen offset:2048 sc1
    buffer_store_dwordx4 v[232:235], v51, s[24:27], 0 offen offset:3072 sc1
    buffer_store_dwordx4 v[236:239], v51, s[24:27], s55 offen offset:0 sc1
    buffer_store_dwordx4 v[240:243], v51, s[24:27], s55 offen offset:1024 sc1
L_ost_done:
    ds_write_b128 v62, v[220:223] offset:0
    ds_write_b128 v62, v[224:227] offset:1024
    ds_write_b128 v62, v[228:231] offset:2048
    ds_write_b128 v62, v[232:235] offset:3072
    ds_write_b128 v62, v[236:239] offset:4096
    ds_write_b128 v62, v[240:243] offset:5120
    s_waitcnt vmcnt(14)
    ds_read_b64_tr_b16 a[112:113], v52 offset:49152
    ds_read_b64_tr_b16 a[116:117], v52 offset:49160
    ds_read_b64_tr_b16 a[114:115], v52 offset:50176
    ds_read_b64_tr_b16 a[118:119], v52 offset:50184
    ds_read_b64_tr_b16 a[120:121], v52 offset:51200
    ds_read_b64_tr_b16 a[124:125], v52 offset:51208
    ds_read_b64_tr_b16 a[122:123], v52 offset:52224
    ds_read_b64_tr_b16 a[126:127], v52 offset:52232
    s_waitcnt lgkmcnt(14)
    s_add_u32 m0, s47, 32768
    s_nop 0
    buffer_load_dwordx4 v10, s[28:31], s65 offen offset:0  lds
    buffer_load_dwordx4 v11, s[28:31], s65 offen offset:1024  lds
    buffer_load_dwordx4 v12, s[28:31], s65 offen offset:2048  lds
    buffer_load_dwordx4 v13, s[28:31], s65 offen offset:3072  lds
    s_waitcnt vmcnt(14)
    ds_read_b64_tr_b16 a[128:129], v52 offset:0
    ds_read_b64_tr_b16 a[132:133], v52 offset:8
    ds_read_b64_tr_b16 a[130:131], v52 offset:1024
    ds_read_b64_tr_b16 a[134:135], v52 offset:1032
    ds_read_b64_tr_b16 a[136:137], v52 offset:2048
    ds_read_b64_tr_b16 a[140:141], v52 offset:2056
    ds_read_b64_tr_b16 a[138:139], v52 offset:3072
    ds_read_b64_tr_b16 a[142:143], v52 offset:3080
    s_waitcnt lgkmcnt(8)
    s_add_u32 m0, s47, 49152
    s_nop 0
    buffer_load_dwordx4 v14, s[28:31], s65 offen offset:0  lds
    buffer_load_dwordx4 v15, s[28:31], s65 offen offset:1024  lds
    buffer_load_dwordx4 v16, s[28:31], s65 offen offset:2048  lds
    buffer_load_dwordx4 v56, s[28:31], s65 offen offset:3072  lds
    s_waitcnt vmcnt(8)
    s_mov_b64 exec, 1
    s_cmp_eq_u32 s54, 1
    s_cbranch_scc0 L_fl_rem
    buffer_store_dword v61, v59, s[24:27], 0 offen
    s_branch L_fl_done
L_fl_rem:
    buffer_store_dword v61, v59, s[24:27], 0 offen sc1
L_fl_done:
    s_mov_b64 exec, -1
    ds_read_b64_tr_b16 a[144:145], v52 offset:16384
    ds_read_b64_tr_b16 a[148:149], v52 offset:16392
    ds_read_b64_tr_b16 a[146:147], v52 offset:17408
    ds_read_b64_tr_b16 a[150:151], v52 offset:17416
    ds_read_b64_tr_b16 a[152:153], v52 offset:18432
    ds_read_b64_tr_b16 a[156:157], v52 offset:18440
    ds_read_b64_tr_b16 a[154:155], v52 offset:19456
    ds_read_b64_tr_b16 a[158:159], v52 offset:19464
    s_waitcnt lgkmcnt(8)
    s_add_u32 m0, s47, 0
    s_nop 0
    buffer_load_dwordx4 v10, s[28:31], s66 offen offset:0  lds
    buffer_load_dwordx4 v11, s[28:31], s66 offen offset:1024  lds
    buffer_load_dwordx4 v12, s[28:31], s66 offen offset:2048  lds
    buffer_load_dwordx4 v13, s[28:31], s66 offen offset:3072  lds
    s_waitcnt vmcnt(9)
    ds_read_b64_tr_b16 a[160:161], v52 offset:32768
    ds_read_b64_tr_b16 a[164:165], v52 offset:32776
    ds_read_b64_tr_b16 a[162:163], v52 offset:33792
    ds_read_b64_tr_b16 a[166:167], v52 offset:33800
    ds_read_b64_tr_b16 a[168:169], v52 offset:34816
    ds_read_b64_tr_b16 a[172:173], v52 offset:34824
    ds_read_b64_tr_b16 a[170:171], v52 offset:35840
    ds_read_b64_tr_b16 a[174:175], v52 offset:35848
    s_waitcnt lgkmcnt(8)
    s_add_u32 m0, s47, 16384
    s_nop 0
    buffer_load_dwordx4 v14, s[28:31], s66 offen offset:0  lds
    buffer_load_dwordx4 v15, s[28:31], s66 offen offset:1024  lds
    buffer_load_dwordx4 v16, s[28:31], s66 offen offset:2048  lds
    buffer_load_dwordx4 v56, s[28:31], s66 offen offset:3072  lds
    s_barrier
    ds_read_b128 v[68:71], v23 offset:0
    ds_read_b128 v[72:75], v23 offset:3072
    ds_read_b128 v[76:79], v23 offset:6144
    ds_read_b128 v[80:83], v23 offset:9216
    ds_read_b128 v[84:87], v24 offset:0
    ds_read_b128 v[88:91], v24 offset:3072
    ds_read_b128 v[92:95], v24 offset:6144
    ds_read_b128 v[96:99], v24 offset:9216
    s_waitcnt lgkmcnt(4)
    v_mfma_f32_16x16x32_bf16 v[124:127], a[0:3], v[68:71], 0
    s_waitcnt vmcnt(9)
    ds_read_b64_tr_b16 a[176:177], v52 offset:49152
    v_mfma_f32_16x16x32_bf16 v[128:131], a[4:7], v[68:71], 0
    ds_read_b64_tr_b16 a[180:181], v52 offset:49160
    ds_read_b64_tr_b16 a[178:179], v52 offset:50176
    v_mfma_f32_16x16x32_bf16 v[124:127], a[8:11], v[72:75], v[124:127]
    ds_read_b64_tr_b16 a[182:183], v52 offset:50184
    ds_read_b64_tr_b16 a[184:185], v52 offset:51200
    v_mfma_f32_16x16x32_bf16 v[128:131], a[12:15], v[72:75], v[128:131]
    ds_read_b64_tr_b16 a[188:189], v52 offset:51208
    ds_read_b64_tr_b16 a[186:187], v52 offset:52224
    v_mfma_f32_16x16x32_bf16 v[124:127], a[16:19], v[76:79], v[124:127]
    ds_read_b64_tr_b16 a[190:191], v52 offset:52232
    v_mfma_f32_16x16x32_bf16 v[128:131], a[20:23], v[76:79], v[128:131]
    s_add_u32 m0, s47, 32768
    s_nop 0
    buffer_load_dwordx4 v10, s[28:31], s67 offen offset:0  lds
    buffer_load_dwordx4 v11, s[28:31], s67 offen offset:1024  lds
    v_mfma_f32_16x16x32_bf16 v[124:127], a[24:27], v[80:83], v[124:127]
    buffer_load_dwordx4 v12, s[28:31], s67 offen offset:2048  lds
    buffer_load_dwordx4 v13, s[28:31], s67 offen offset:3072  lds
    v_mfma_f32_16x16x32_bf16 v[128:131], a[28:31], v[80:83], v[128:131]
    s_waitcnt vmcnt(8)
    ds_read_b64_tr_b16 a[192:193], v52 offset:0
    ds_read_b64_tr_b16 a[196:197], v52 offset:8
    ds_read_b64_tr_b16 a[194:195], v52 offset:1024
    ds_read_b64_tr_b16 a[198:199], v52 offset:1032
    ds_read_b64_tr_b16 a[200:201], v52 offset:2048
    ds_read_b64_tr_b16 a[204:205], v52 offset:2056
    ds_read_b64_tr_b16 a[202:203], v52 offset:3072
    ds_read_b64_tr_b16 a[206:207], v52 offset:3080
    s_waitcnt lgkmcnt(8)
    s_add_u32 m0, s47, 49152
    s_nop 0
    buffer_load_dwordx4 v14, s[28:31], s67 offen offset:0  lds
    buffer_load_dwordx4 v15, s[28:31], s67 offen offset:1024  lds
    buffer_load_dwordx4 v16, s[28:31], s67 offen offset:2048  lds
    buffer_load_dwordx4 v56, s[28:31], s67 offen offset:3072  lds
    buffer_load_dword v7, v60, s[24:27], 0 offen sc1
    ds_read_b128 v[100:103], v25 offset:0
    ds_read_b128 v[104:107], v25 offset:3072
    ds_read_b128 v[108:111], v25 offset:6144
    ds_read_b128 v[112:115], v25 offset:9216
    v_mfma_f32_16x16x32_bf16 v[132:135], a[0:3], v[84:87], 0
    ds_read_b128 v[68:71], v26 offset:0
    v_mfma_f32_16x16x32_bf16 v[136:139], a[4:7], v[84:87], 0
    ds_read_b128 v[72:75], v26 offset:3072
    v_mfma_f32_16x16x32_bf16 v[132:135], a[8:11], v[88:91], v[132:135]
    ds_read_b128 v[76:79], v26 offset:6144
    v_mfma_f32_16x16x32_bf16 v[136:139], a[12:15], v[88:91], v[136:139]
    ds_read_b128 v[80:83], v26 offset:9216
    v_mfma_f32_16x16x32_bf16 v[132:135], a[16:19], v[92:95], v[132:135]
    v_mfma_f32_16x16x32_bf16 v[136:139], a[20:23], v[92:95], v[136:139]
    v_mfma_f32_16x16x32_bf16 v[132:135], a[24:27], v[96:99], v[132:135]
    v_mfma_f32_16x16x32_bf16 v[136:139], a[28:31], v[96:99], v[136:139]
    s_waitcnt vmcnt(9)
    ds_read_b64_tr_b16 a[208:209], v52 offset:16384
    ds_read_b64_tr_b16 a[212:213], v52 offset:16392
    ds_read_b64_tr_b16 a[210:211], v52 offset:17408
    ds_read_b64_tr_b16 a[214:215], v52 offset:17416
    ds_read_b64_tr_b16 a[216:217], v52 offset:18432
    ds_read_b64_tr_b16 a[220:221], v52 offset:18440
    ds_read_b64_tr_b16 a[218:219], v52 offset:19456
    ds_read_b64_tr_b16 a[222:223], v52 offset:19464
    s_waitcnt vmcnt(5)
    ds_read_b64_tr_b16 a[224:225], v52 offset:32768
    ds_read_b64_tr_b16 a[228:229], v52 offset:32776
    ds_read_b64_tr_b16 a[226:227], v52 offset:33792
    ds_read_b64_tr_b16 a[230:231], v52 offset:33800
    ds_read_b64_tr_b16 a[232:233], v52 offset:34816
    ds_read_b64_tr_b16 a[236:237], v52 offset:34824
    ds_read_b64_tr_b16 a[234:235], v52 offset:35840
    ds_read_b64_tr_b16 a[238:239], v52 offset:35848
    s_waitcnt vmcnt(1)
    ds_read_b64_tr_b16 a[240:241], v52 offset:49152
    ds_read_b64_tr_b16 a[244:245], v52 offset:49160
    ds_read_b64_tr_b16 a[242:243], v52 offset:50176
    ds_read_b64_tr_b16 a[246:247], v52 offset:50184
    ds_read_b64_tr_b16 a[248:249], v52 offset:51200
    ds_read_b64_tr_b16 a[252:253], v52 offset:51208
    ds_read_b64_tr_b16 a[250:251], v52 offset:52224
    ds_read_b64_tr_b16 a[254:255], v52 offset:52232
    s_mov_b32 s88, 0
    s_waitcnt vmcnt(0)
    v_cmp_eq_u32 vcc, 0, v7
    s_nop 0
    s_cbranch_vccz L_f1_ok
L_f1_poll:
    buffer_load_dword v6, v60, s[24:27], 0 offen sc1
    s_waitcnt vmcnt(0)
    v_cmp_eq_u32 vcc, 0, v6
    s_add_u32 s88, s88, 1
    s_cbranch_vccz L_f1_ok
    s_cmp_lt_u32 s88, 200000
    s_cbranch_scc1 L_f1_poll
L_f1_ok:
    s_add_u32 m0, s53, 65536
    s_nop 0
    buffer_load_dwordx4 v17, s[24:27], s8 offen sc1 lds
    s_add_u32 m0, s53, 69632
    s_nop 0
    buffer_load_dwordx4 v17, s[24:27], s9 offen sc1 lds
    s_add_u32 m0, s53, 73728
    s_nop 0
    buffer_load_dwordx4 v17, s[24:27], s10 offen sc1 lds
    s_add_u32 m0, s53, 77824
    s_nop 0
    buffer_load_dwordx4 v17, s[24:27], s11 offen sc1 lds
    s_add_u32 m0, s53, 81920
    s_nop 0
    buffer_load_dwordx4 v17, s[24:27], s12 offen sc1 lds
    s_add_u32 m0, s53, 86016
    s_nop 0
    buffer_load_dwordx4 v17, s[24:27], s13 offen sc1 lds
    s_add_u32 m0, s53, 90112
    s_nop 0
    buffer_load_dwordx4 v17, s[24:27], s14 offen sc1 lds
    s_waitcnt lgkmcnt(15)
    v_mfma_f32_16x16x32_bf16 v[140:143], a[0:3], v[100:103], 0
    ds_read_b128 v[84:87], v27 offset:0
    ds_read_b128 v[88:91], v27 offset:3072
    v_mfma_f32_16x16x32_bf16 v[144:147], a[4:7], v[100:103], 0
    ds_read_b128 v[92:95], v27 offset:6144
    ds_read_b128 v[96:99], v27 offset:9216
    v_mfma_f32_16x16x32_bf16 v[140:143], a[8:11], v[104:107], v[140:143]
    s_add_u32 m0, s53, 94208
    s_nop 0
    buffer_load_dwordx4 v18, s[24:27], s8 offen sc1 lds
    s_add_u32 m0, s53, 98304
    s_nop 0
    buffer_load_dwordx4 v18, s[24:27], s9 offen sc1 lds
    v_mfma_f32_16x16x32_bf16 v[144:147], a[12:15], v[104:107], v[144:147]
    s_add_u32 m0, s53, 102400
    s_nop 0
    buffer_load_dwordx4 v18, s[24:27], s10 offen sc1 lds
    v_and_b32 v3, 15, v1
    v_mfma_f32_16x16x32_bf16 v[140:143], a[16:19], v[108:111], v[140:143]
    v_lshrrev_b32 v4, 4, v1
    s_mul_i32 s70, s40, 96
    v_mfma_f32_16x16x32_bf16 v[144:147], a[20:23], v[108:111], v[144:147]
    v_add_u32 v3, s70, v3
    v_lshlrev_b32 v3, 11, v3
    v_mfma_f32_16x16x32_bf16 v[140:143], a[24:27], v[112:115], v[140:143]
    v_lshl_add_u32 v3, v4, 4, v3
    v_mfma_f32_16x16x32_bf16 v[144:147], a[28:31], v[112:115], v[144:147]
    s_xor_b32 s70, s42, 1
    v_mfma_f32_16x16x32_bf16 v[148:151], a[0:3], v[68:71], 0
    ds_read_b128 v[100:103], v28 offset:0
    ds_read_b128 v[104:107], v28 offset:3072
    v_mfma_f32_16x16x32_bf16 v[152:155], a[4:7], v[68:71], 0
    ds_read_b128 v[108:111], v28 offset:6144
    ds_read_b128 v[112:115], v28 offset:9216
    v_mfma_f32_16x16x32_bf16 v[148:151], a[8:11], v[72:75], v[148:151]
    s_add_u32 m0, s53, 106496
    s_nop 0
    buffer_load_dwordx4 v18, s[24:27], s11 offen sc1 lds
    s_add_u32 m0, s53, 110592
    s_nop 0
    buffer_load_dwordx4 v18, s[24:27], s12 offen sc1 lds
    v_mfma_f32_16x16x32_bf16 v[152:155], a[12:15], v[72:75], v[152:155]
    s_add_u32 m0, s53, 139264
    s_nop 0
    buffer_load_dwordx4 v18, s[24:27], s13 offen sc1 lds
    s_lshl_b32 s70, s70, 8
    v_mfma_f32_16x16x32_bf16 v[148:151], a[16:19], v[76:79], v[148:151]
    s_lshl_b32 s71, s44, 6
    s_add_u32 s70, s70, s71
    v_mfma_f32_16x16x32_bf16 v[152:155], a[20:23], v[76:79], v[152:155]
    v_add_u32 v3, s70, v3
    s_cmp_ge_u32 s73, 12288
    s_cselect_b32 s70, 12288, 0
    v_mfma_f32_16x16x32_bf16 v[148:151], a[24:27], v[80:83], v[148:151]
    s_sub_u32 s71, s73, s70
    v_mfma_f32_16x16x32_bf16 v[152:155], a[28:31], v[80:83], v[152:155]
    s_lshl_b32 s71, s71, 5
    s_waitcnt lgkmcnt(4)
    v_mfma_f32_16x16x32_bf16 v[156:159], a[0:3], v[84:87], 0
    s_add_u32 m0, s53, 143360
    s_nop 0
    buffer_load_dwordx4 v18, s[24:27], s14 offen sc1 lds
    v_mfma_f32_16x16x32_bf16 v[160:163], a[4:7], v[84:87], 0
    s_lshl_b32 s70, s70, 3
    v_mfma_f32_16x16x32_bf16 v[156:159], a[8:11], v[88:91], v[156:159]
    s_add_u32 s60, s70, s71
    v_mfma_f32_16x16x32_bf16 v[160:163], a[12:15], v[88:91], v[160:163]
    s_cmp_ge_u32 s72, 12288
    s_cselect_b32 s70, 12288, 0
    v_mfma_f32_16x16x32_bf16 v[156:159], a[16:19], v[92:95], v[156:159]
    s_sub_u32 s71, s72, s70
    v_mfma_f32_16x16x32_bf16 v[160:163], a[20:23], v[92:95], v[160:163]
    s_lshl_b32 s71, s71, 5
    v_mfma_f32_16x16x32_bf16 v[156:159], a[24:27], v[96:99], v[156:159]
    s_lshl_b32 s70, s70, 3
    v_mfma_f32_16x16x32_bf16 v[160:163], a[28:31], v[96:99], v[160:163]
    s_add_u32 s61, s70, s71
    s_waitcnt vmcnt(7)
    s_barrier
    s_waitcnt lgkmcnt(0)
    v_mfma_f32_16x16x32_bf16 v[164:167], a[0:3], v[100:103], 0
    ds_read_b128 v[68:71], v63 offset:0
    ds_read_b128 v[72:75], v63 offset:1024
    v_mfma_f32_16x16x32_bf16 v[168:171], a[4:7], v[100:103], 0
    ds_read_b128 v[76:79], v63 offset:2048
    ds_read_b128 v[80:83], v63 offset:3072
    v_mfma_f32_16x16x32_bf16 v[164:167], a[8:11], v[104:107], v[164:167]
    ds_read_b128 v[84:87], v63 offset:4096
    ds_read_b128 v[88:91], v63 offset:5120
    v_mfma_f32_16x16x32_bf16 v[168:171], a[12:15], v[104:107], v[168:171]
    ds_read_b128 v[92:95], v63 offset:6144
    ds_read_b128 v[96:99], v63 offset:7168
    v_mfma_f32_16x16x32_bf16 v[164:167], a[16:19], v[108:111], v[164:167]
    s_add_u32 m0, s53, 0
    s_nop 0
    buffer_load_dwordx4 v19, s[24:27], s8 offen sc1 lds
    v_mfma_f32_16x16x32_bf16 v[168:171], a[20:23], v[108:111], v[168:171]
    s_add_u32 m0, s53, 4096
    s_nop 0
    buffer_load_dwordx4 v19, s[24:27], s9 offen sc1 lds
    v_mfma_f32_16x16x32_bf16 v[164:167], a[24:27], v[112:115], v[164:167]
    s_lshl_b32 s68, 1, s41
    v_mfma_f32_16x16x32_bf16 v[168:171], a[28:31], v[112:115], v[168:171]
    s_xor_b32 s68, s68, 15
    s_waitcnt lgkmcnt(4)
    v_mfma_f32_16x16x32_bf16 v[124:127], a[32:35], v[68:71], v[124:127]
    ds_read_b128 v[100:103], v63 offset:8192
    v_mfma_f32_16x16x32_bf16 v[128:131], a[36:39], v[68:71], v[128:131]
    ds_read_b128 v[104:107], v63 offset:9216
    v_mfma_f32_16x16x32_bf16 v[124:127], a[40:43], v[72:75], v[124:127]
    ds_read_b128 v[108:111], v63 offset:10240
    v_mfma_f32_16x16x32_bf16 v[128:131], a[44:47], v[72:75], v[128:131]
    ds_read_b128 v[112:115], v63 offset:11264
    v_mfma_f32_16x16x32_bf16 v[124:127], a[48:51], v[76:79], v[124:127]
    s_add_u32 m0, s53, 8192
    s_nop 0
    buffer_load_dwordx4 v19, s[24:27], s10 offen sc1 lds
    v_mfma_f32_16x16x32_bf16 v[128:131], a[52:55], v[76:79], v[128:131]
    s_add_u32 m0, s53, 12288
    s_nop 0
    buffer_load_dwordx4 v19, s[24:27], s11 offen sc1 lds
    v_mfma_f32_16x16x32_bf16 v[124:127], a[56:59], v[80:83], v[124:127]
    v_mfma_f32_16x16x32_bf16 v[128:131], a[60:63], v[80:83], v[128:131]
    s_waitcnt lgkmcnt(4)
    v_mfma_f32_16x16x32_bf16 v[124:127], a[64:67], v[84:87], v[124:127]
    ds_read_b128 v[68:71], v63 offset:12288
    v_mfma_f32_16x16x32_bf16 v[128:131], a[68:71], v[84:87], v[128:131]
    ds_read_b128 v[72:75], v63 offset:13312
    v_mfma_f32_16x16x32_bf16 v[124:127], a[72:75], v[88:91], v[124:127]
    ds_read_b128 v[76:79], v63 offset:14336
    v_mfma_f32_16x16x32_bf16 v[128:131], a[76:79], v[88:91], v[128:131]
    ds_read_b128 v[80:83], v63 offset:15360
    v_mfma_f32_16x16x32_bf16 v[124:127], a[80:83], v[92:95], v[124:127]
    s_add_u32 m0, s53, 16384
    s_nop 0
    buffer_load_dwordx4 v19, s[24:27], s12 offen sc1 lds
    v_mfma_f32_16x16x32_bf16 v[128:131], a[84:87], v[92:95], v[128:131]
    s_add_u32 m0, s53, 20480
    s_nop 0
    buffer_load_dwordx4 v19, s[24:27], s13 offen sc1 lds
    v_mfma_f32_16x16x32_bf16 v[124:127], a[88:91], v[96:99], v[124:127]
    v_mfma_f32_16x16x32_bf16 v[128:131], a[92:95], v[96:99], v[128:131]
    s_waitcnt lgkmcnt(4)
    v_mfma_f32_16x16x32_bf16 v[124:127], a[96:99], v[100:103], v[124:127]
    ds_read_b128 v[84:87], v63 offset:16384
    v_mfma_f32_16x16x32_bf16 v[128:131], a[100:103], v[100:103], v[128:131]
    ds_read_b128 v[88:91], v63 offset:17408
    v_mfma_f32_16x16x32_bf16 v[124:127], a[104:107], v[104:107], v[124:127]
    ds_read_b128 v[92:95], v63 offset:18432
    v_mfma_f32_16x16x32_bf16 v[128:131], a[108:111], v[104:107], v[128:131]
    ds_read_b128 v[96:99], v63 offset:19456
    v_mfma_f32_16x16x32_bf16 v[124:127], a[112:115], v[108:111], v[124:127]
    s_add_u32 m0, s53, 24576
    s_nop 0
    buffer_load_dwordx4 v19, s[24:27], s14 offen sc1 lds
    v_mfma_f32_16x16x32_bf16 v[128:131], a[116:119], v[108:111], v[128:131]
    s_add_u32 m0, s53, 28672
    s_nop 0
    buffer_load_dwordx4 v20, s[24:27], s8 offen sc1 lds
    v_mfma_f32_16x16x32_bf16 v[124:127], a[120:123], v[112:115], v[124:127]
    v_mfma_f32_16x16x32_bf16 v[128:131], a[124:127], v[112:115], v[128:131]
    s_waitcnt lgkmcnt(4)
    v_mfma_f32_16x16x32_bf16 v[124:127], a[128:131], v[68:71], v[124:127]
    ds_read_b128 v[100:103], v63 offset:20480
    v_mfma_f32_16x16x32_bf16 v[128:131], a[132:135], v[68:71], v[128:131]
    ds_read_b128 v[104:107], v63 offset:21504
    v_mfma_f32_16x16x32_bf16 v[124:127], a[136:139], v[72:75], v[124:127]
    ds_read_b128 v[108:111], v63 offset:22528
    v_mfma_f32_16x16x32_bf16 v[128:131], a[140:143], v[72:75], v[128:131]
    ds_read_b128 v[112:115], v63 offset:23552
    v_mfma_f32_16x16x32_bf16 v[124:127], a[144:147], v[76:79], v[124:127]
    s_add_u32 m0, s53, 32768
    s_nop 0
    buffer_load_dwordx4 v20, s[24:27], s9 offen sc1 lds
    v_mfma_f32_16x16x32_bf16 v[128:131], a[148:151], v[76:79], v[128:131]
    s_add_u32 m0, s53, 36864
    s_nop 0
    buffer_load_dwordx4 v20, s[24:27], s10 offen sc1 lds
    v_mfma_f32_16x16x32_bf16 v[124:127], a[152:155], v[80:83], v[124:127]
    v_mfma_f32_16x16x32_bf16 v[128:131], a[156:159], v[80:83], v[128:131]
    s_waitcnt lgkmcnt(4)
    v_mfma_f32_16x16x32_bf16 v[124:127], a[160:163], v[84:87], v[124:127]
    ds_read_b128 v[68:71], v63 offset:24576
    v_mfma_f32_16x16x32_bf16 v[128:131], a[164:167], v[84:87], v[128:131]
    ds_read_b128 v[72:75], v63 offset:25600
    v_mfma_f32_16x16x32_bf16 v[124:127], a[168:171], v[88:91], v[124:127]
    ds_read_b128 v[76:79], v63 offset:26624
    v_mfma_f32_16x16x32_bf16 v[128:131], a[172:175], v[88:91], v[128:131]
    ds_read_b128 v[80:83], v63 offset:27648
    v_mfma_f32_16x16x32_bf16 v[124:127], a[176:179], v[92:95], v[124:127]
    s_add_u32 m0, s53, 40960
    s_nop 0
    buffer_load_dwordx4 v20, s[24:27], s11 offen sc1 lds
    v_mfma_f32_16x16x32_bf16 v[128:131], a[180:183], v[92:95], v[128:131]
    s_add_u32 m0, s53, 45056
    s_nop 0
    buffer_load_dwordx4 v20, s[24:27], s12 offen sc1 lds
    v_mfma_f32_16x16x32_bf16 v[124:127], a[184:187], v[96:99], v[124:127]
    v_mfma_f32_16x16x32_bf16 v[128:131], a[188:191], v[96:99], v[128:131]
    s_waitcnt vmcnt(12)
    s_barrier
    s_waitcnt lgkmcnt(4)
    v_mfma_f32_16x16x32_bf16 v[124:127], a[192:195], v[100:103], v[124:127]
    ds_read_b128 v[84:87], v63 offset:28672
    v_mfma_f32_16x16x32_bf16 v[128:131], a[196:199], v[100:103], v[128:131]
    ds_read_b128 v[88:91], v63 offset:29696
    v_mfma_f32_16x16x32_bf16 v[124:127], a[200:203], v[104:107], v[124:127]
    ds_read_b128 v[92:95], v63 offset:30720
    v_mfma_f32_16x16x32_bf16 v[128:131], a[204:207], v[104:107], v[128:131]
    ds_read_b128 v[96:99], v63 offset:31744
    v_mfma_f32_16x16x32_bf16 v[124:127], a[208:211], v[108:111], v[124:127]
    s_add_u32 m0, s53, 49152
    s_nop 0
    buffer_load_dwordx4 v20, s[24:27], s13 offen sc1 lds
    v_mfma_f32_16x16x32_bf16 v[128:131], a[212:215], v[108:111], v[128:131]
    s_add_u32 m0, s53, 53248
    s_nop 0
    buffer_load_dwordx4 v20, s[24:27], s14 offen sc1 lds
    v_mfma_f32_16x16x32_bf16 v[124:127], a[216:219], v[112:115], v[124:127]
    v_mfma_f32_16x16x32_bf16 v[128:131], a[220:223], v[112:115], v[128:131]
    s_waitcnt lgkmcnt(4)
    v_mfma_f32_16x16x32_bf16 v[124:127], a[224:227], v[68:71], v[124:127]
    ds_read_b128 v[100:103], v63 offset:32768
    v_mfma_f32_16x16x32_bf16 v[128:131], a[228:231], v[68:71], v[128:131]
    ds_read_b128 v[104:107], v63 offset:33792
    v_mfma_f32_16x16x32_bf16 v[124:127], a[232:235], v[72:75], v[124:127]
    ds_read_b128 v[108:111], v63 offset:34816
    v_mfma_f32_16x16x32_bf16 v[128:131], a[236:239], v[72:75], v[128:131]
    ds_read_b128 v[112:115], v63 offset:35840
    v_mfma_f32_16x16x32_bf16 v[124:127], a[240:243], v[76:79], v[124:127]
    s_add_u32 m0, s53, 57344
    s_nop 0
    buffer_load_dwordx4 v21, s[24:27], s8 offen sc1 lds
    v_mfma_f32_16x16x32_bf16 v[128:131], a[244:247], v[76:79], v[128:131]
    s_add_u32 m0, s53, 61440
    s_nop 0
    buffer_load_dwordx4 v21, s[24:27], s9 offen sc1 lds
    v_mfma_f32_16x16x32_bf16 v[124:127], a[248:251], v[80:83], v[124:127]
    v_mfma_f32_16x16x32_bf16 v[128:131], a[252:255], v[80:83], v[128:131]
    s_waitcnt lgkmcnt(4)
    v_mfma_f32_16x16x32_bf16 v[132:135], a[32:35], v[84:87], v[132:135]
    ds_read_b128 v[68:71], v63 offset:36864
    v_mfma_f32_16x16x32_bf16 v[136:139], a[36:39], v[84:87], v[136:139]
    ds_read_b128 v[72:75], v63 offset:37888
    v_mfma_f32_16x16x32_bf16 v[132:135], a[40:43], v[88:91], v[132:135]
    ds_read_b128 v[76:79], v63 offset:38912
    v_mfma_f32_16x16x32_bf16 v[136:139], a[44:47], v[88:91], v[136:139]
    ds_read_b128 v[80:83], v63 offset:39936
    v_mfma_f32_16x16x32_bf16 v[132:135], a[48:51], v[92:95], v[132:135]
    s_add_u32 m0, s53, 147456
    s_nop 0
    buffer_load_dwordx4 v21, s[24:27], s10 offen sc1 lds
    v_mfma_f32_16x16x32_bf16 v[136:139], a[52:55], v[92:95], v[136:139]
    s_add_u32 m0, s53, 151552
    s_nop 0
    buffer_load_dwordx4 v21, s[24:27], s11 offen sc1 lds
    v_mfma_f32_16x16x32_bf16 v[132:135], a[56:59], v[96:99], v[132:135]
    v_mfma_f32_16x16x32_bf16 v[136:139], a[60:63], v[96:99], v[136:139]
    s_waitcnt lgkmcnt(4)
    v_mfma_f32_16x16x32_bf16 v[132:135], a[64:67], v[100:103], v[132:135]
    ds_read_b128 v[84:87], v63 offset:40960
    v_mfma_f32_16x16x32_bf16 v[136:139], a[68:71], v[100:103], v[136:139]
    ds_read_b128 v[88:91], v63 offset:41984
    v_mfma_f32_16x16x32_bf16 v[132:135], a[72:75], v[104:107], v[132:135]
    ds_read_b128 v[92:95], v63 offset:43008
    v_mfma_f32_16x16x32_bf16 v[136:139], a[76:79], v[104:107], v[136:139]
    ds_read_b128 v[96:99], v63 offset:44032
    v_mfma_f32_16x16x32_bf16 v[132:135], a[80:83], v[108:111], v[132:135]
    s_add_u32 m0, s53, 155648
    s_nop 0
    buffer_load_dwordx4 v21, s[24:27], s12 offen sc1 lds
    v_mfma_f32_16x16x32_bf16 v[136:139], a[84:87], v[108:111], v[136:139]
    s_add_u32 m0, s53, 159744
    s_nop 0
    buffer_load_dwordx4 v21, s[24:27], s13 offen sc1 lds
    v_mfma_f32_16x16x32_bf16 v[132:135], a[88:91], v[112:115], v[132:135]
    v_mfma_f32_16x16x32_bf16 v[136:139], a[92:95], v[112:115], v[136:139]
    s_waitcnt lgkmcnt(4)
    v_mfma_f32_16x16x32_bf16 v[132:135], a[96:99], v[68:71], v[132:135]
    ds_read_b128 v[100:103], v63 offset:45056
    ds_read_b128 v[104:107], v63 offset:46080
    v_mfma_f32_16x16x32_bf16 v[136:139], a[100:103], v[68:71], v[136:139]
    ds_read_b128 v[108:111], v63 offset:47104
    v_mfma_f32_16x16x32_bf16 v[132:135], a[104:107], v[72:75], v[132:135]
    ds_read_b128 v[112:115], v63 offset:48128
    v_mfma_f32_16x16x32_bf16 v[136:139], a[108:111], v[72:75], v[136:139]
    s_add_u32 m0, s53, 114688
    s_nop 0
    buffer_load_dwordx4 v21, s[24:27], s14 offen sc1 lds
    v_mfma_f32_16x16x32_bf16 v[132:135], a[112:115], v[76:79], v[132:135]
    v_mov_b32 v252, -1
    v_mfma_f32_16x16x32_bf16 v[136:139], a[116:119], v[76:79], v[136:139]
    v_mov_b32 v253, -1
    v_mfma_f32_16x16x32_bf16 v[132:135], a[120:123], v[80:83], v[132:135]
    v_mov_b32 v254, -1
    v_mfma_f32_16x16x32_bf16 v[136:139], a[124:127], v[80:83], v[136:139]
    v_mov_b32 v255, -1
    s_waitcnt lgkmcnt(4)
    v_mfma_f32_16x16x32_bf16 v[132:135], a[128:131], v[84:87], v[132:135]
    ds_read_b128 v[68:71], v64 offset:8192
    v_mfma_f32_16x16x32_bf16 v[136:139], a[132:135], v[84:87], v[136:139]
    ds_read_b128 v[72:75], v64 offset:9216
    v_mfma_f32_16x16x32_bf16 v[132:135], a[136:139], v[88:91], v[132:135]
    ds_read_b128 v[76:79], v64 offset:10240
    v_mfma_f32_16x16x32_bf16 v[136:139], a[140:143], v[88:91], v[136:139]
    ds_read_b128 v[80:83], v64 offset:11264
    v_mfma_f32_16x16x32_bf16 v[132:135], a[144:147], v[92:95], v[132:135]
    buffer_store_dwordx4 v[252:255], v53, s[24:27], s74 offen sc1
    v_mfma_f32_16x16x32_bf16 v[136:139], a[148:151], v[92:95], v[136:139]
    v_mfma_f32_16x16x32_bf16 v[132:135], a[152:155], v[96:99], v[132:135]
    v_mfma_f32_16x16x32_bf16 v[136:139], a[156:159], v[96:99], v[136:139]
    s_waitcnt lgkmcnt(4)
    v_mfma_f32_16x16x32_bf16 v[132:135], a[160:163], v[100:103], v[132:135]
    ds_read_b128 v[84:87], v64 offset:12288
    v_mfma_f32_16x16x32_bf16 v[136:139], a[164:167], v[100:103], v[136:139]
    ds_read_b128 v[88:91], v64 offset:13312
    v_mfma_f32_16x16x32_bf16 v[132:135], a[168:171], v[104:107], v[132:135]
    ds_read_b128 v[92:95], v64 offset:14336
    v_mfma_f32_16x16x32_bf16 v[136:139], a[172:175], v[104:107], v[136:139]
    ds_read_b128 v[96:99], v64 offset:15360
    v_mfma_f32_16x16x32_bf16 v[132:135], a[176:179], v[108:111], v[132:135]
    buffer_store_dwordx4 v[252:255], v53, s[24:27], s75 offen sc1
    v_mfma_f32_16x16x32_bf16 v[136:139], a[180:183], v[108:111], v[136:139]
    v_mfma_f32_16x16x32_bf16 v[132:135], a[184:187], v[112:115], v[132:135]
    v_mfma_f32_16x16x32_bf16 v[136:139], a[188:191], v[112:115], v[136:139]
    s_waitcnt vmcnt(16)
    s_barrier
    s_waitcnt lgkmcnt(4)
    v_mfma_f32_16x16x32_bf16 v[132:135], a[192:195], v[68:71], v[132:135]
    ds_read_b128 v[100:103], v53 offset:0
    v_mfma_f32_16x16x32_bf16 v[136:139], a[196:199], v[68:71], v[136:139]
    ds_read_b128 v[104:107], v53 offset:1024
    v_mfma_f32_16x16x32_bf16 v[132:135], a[200:203], v[72:75], v[132:135]
    ds_read_b128 v[108:111], v53 offset:2048
    v_mfma_f32_16x16x32_bf16 v[136:139], a[204:207], v[72:75], v[136:139]
    ds_read_b128 v[112:115], v53 offset:3072
    v_mfma_f32_16x16x32_bf16 v[132:135], a[208:211], v[76:79], v[132:135]
    s_add_u32 m0, s53, 65536
    s_nop 0
    buffer_load_dwordx4 v22, s[24:27], s8 offen sc1 lds
    v_mfma_f32_16x16x32_bf16 v[136:139], a[212:215], v[76:79], v[136:139]
    s_add_u32 m0, s53, 69632
    s_nop 0
    buffer_load_dwordx4 v22, s[24:27], s9 offen sc1 lds
    v_mfma_f32_16x16x32_bf16 v[132:135], a[216:219], v[80:83], v[132:135]
    buffer_store_dwordx4 v[252:255], v53, s[24:27], s76 offen sc1
    v_mfma_f32_16x16x32_bf16 v[136:139], a[220:223], v[80:83], v[136:139]
    s_waitcnt lgkmcnt(4)
    v_mfma_f32_16x16x32_bf16 v[132:135], a[224:227], v[84:87], v[132:135]
    ds_read_b128 v[68:71], v53 offset:4096
    v_mfma_f32_16x16x32_bf16 v[136:139], a[228:231], v[84:87], v[136:139]
    ds_read_b128 v[72:75], v53 offset:5120
    v_mfma_f32_16x16x32_bf16 v[132:135], a[232:235], v[88:91], v[132:135]
    ds_read_b128 v[76:79], v53 offset:6144
    v_mfma_f32_16x16x32_bf16 v[136:139], a[236:239], v[88:91], v[136:139]
    ds_read_b128 v[80:83], v53 offset:7168
    v_mfma_f32_16x16x32_bf16 v[132:135], a[240:243], v[92:95], v[132:135]
    s_add_u32 m0, s53, 73728
    s_nop 0
    buffer_load_dwordx4 v22, s[24:27], s10 offen sc1 lds
    v_mfma_f32_16x16x32_bf16 v[136:139], a[244:247], v[92:95], v[136:139]
    s_add_u32 m0, s53, 77824
    s_nop 0
    buffer_load_dwordx4 v22, s[24:27], s11 offen sc1 lds
    v_mfma_f32_16x16x32_bf16 v[132:135], a[248:251], v[96:99], v[132:135]
    v_mfma_f32_16x16x32_bf16 v[136:139], a[252:255], v[96:99], v[136:139]
    s_waitcnt lgkmcnt(4)
    v_mfma_f32_16x16x32_bf16 v[140:143], a[32:35], v[100:103], v[140:143]
    ds_read_b128 v[84:87], v53 offset:8192
    v_mfma_f32_16x16x32_bf16 v[144:147], a[36:39], v[100:103], v[144:147]
    ds_read_b128 v[88:91], v53 offset:9216
    v_mfma_f32_16x16x32_bf16 v[140:143], a[40:43], v[104:107], v[140:143]
    ds_read_b128 v[92:95], v53 offset:10240
    v_mfma_f32_16x16x32_bf16 v[144:147], a[44:47], v[104:107], v[144:147]
    ds_read_b128 v[96:99], v53 offset:11264
    v_mfma_f32_16x16x32_bf16 v[140:143], a[48:51], v[108:111], v[140:143]
    s_add_u32 m0, s53, 81920
    s_nop 0
    buffer_load_dwordx4 v22, s[24:27], s12 offen sc1 lds
    v_mfma_f32_16x16x32_bf16 v[144:147], a[52:55], v[108:111], v[144:147]
    s_add_u32 m0, s53, 86016
    s_nop 0
    buffer_load_dwordx4 v22, s[24:27], s13 offen sc1 lds
    v_mfma_f32_16x16x32_bf16 v[140:143], a[56:59], v[112:115], v[140:143]
    v_mfma_f32_16x16x32_bf16 v[144:147], a[60:63], v[112:115], v[144:147]
    s_waitcnt lgkmcnt(4)
    v_mfma_f32_16x16x32_bf16 v[140:143], a[64:67], v[68:71], v[140:143]
    ds_read_b128 v[100:103], v53 offset:12288
    v_mfma_f32_16x16x32_bf16 v[144:147], a[68:71], v[68:71], v[144:147]
    ds_read_b128 v[104:107], v53 offset:13312
    v_mfma_f32_16x16x32_bf16 v[140:143], a[72:75], v[72:75], v[140:143]
    ds_read_b128 v[108:111], v53 offset:14336
    v_mfma_f32_16x16x32_bf16 v[144:147], a[76:79], v[72:75], v[144:147]
    ds_read_b128 v[112:115], v53 offset:15360
    v_mfma_f32_16x16x32_bf16 v[140:143], a[80:83], v[76:79], v[140:143]
    s_add_u32 m0, s53, 90112
    s_nop 0
    buffer_load_dwordx4 v22, s[24:27], s14 offen sc1 lds
    v_mfma_f32_16x16x32_bf16 v[144:147], a[84:87], v[76:79], v[144:147]
    v_mfma_f32_16x16x32_bf16 v[140:143], a[88:91], v[80:83], v[140:143]
    v_mfma_f32_16x16x32_bf16 v[144:147], a[92:95], v[80:83], v[144:147]
    s_waitcnt lgkmcnt(4)
    v_mfma_f32_16x16x32_bf16 v[140:143], a[96:99], v[84:87], v[140:143]
    ds_read_b128 v[68:71], v53 offset:16384
    v_mfma_f32_16x16x32_bf16 v[144:147], a[100:103], v[84:87], v[144:147]
    ds_read_b128 v[72:75], v53 offset:17408
    v_mfma_f32_16x16x32_bf16 v[140:143], a[104:107], v[88:91], v[140:143]
    ds_read_b128 v[76:79], v53 offset:18432
    v_mfma_f32_16x16x32_bf16 v[144:147], a[108:111], v[88:91], v[144:147]
    ds_read_b128 v[80:83], v53 offset:19456
    v_mfma_f32_16x16x32_bf16 v[140:143], a[112:115], v[92:95], v[140:143]
    v_mfma_f32_16x16x32_bf16 v[144:147], a[116:119], v[92:95], v[144:147]
    v_mfma_f32_16x16x32_bf16 v[140:143], a[120:123], v[96:99], v[140:143]
    v_mfma_f32_16x16x32_bf16 v[144:147], a[124:127], v[96:99], v[144:147]
    s_waitcnt lgkmcnt(4)
    v_mfma_f32_16x16x32_bf16 v[140:143], a[128:131], v[100:103], v[140:143]
    ds_read_b128 v[84:87], v53 offset:20480
    v_mfma_f32_16x16x32_bf16 v[144:147], a[132:135], v[100:103], v[144:147]
    ds_read_b128 v[88:91], v53 offset:21504
    v_mfma_f32_16x16x32_bf16 v[140:143], a[136:139], v[104:107], v[140:143]
    ds_read_b128 v[92:95], v53 offset:22528
    v_mfma_f32_16x16x32_bf16 v[144:147], a[140:143], v[104:107], v[144:147]
    ds_read_b128 v[96:99], v53 offset:23552
    v_mfma_f32_16x16x32_bf16 v[140:143], a[144:147], v[108:111], v[140:143]
    v_mfma_f32_16x16x32_bf16 v[144:147], a[148:151], v[108:111], v[144:147]
    v_mfma_f32_16x16x32_bf16 v[140:143], a[152:155], v[112:115], v[140:143]
    v_mfma_f32_16x16x32_bf16 v[144:147], a[156:159], v[112:115], v[144:147]
    s_waitcnt lgkmcnt(4)
    v_mfma_f32_16x16x32_bf16 v[140:143], a[160:163], v[68:71], v[140:143]
    ds_read_b128 v[100:103], v53 offset:24576
    v_mfma_f32_16x16x32_bf16 v[144:147], a[164:167], v[68:71], v[144:147]
    ds_read_b128 v[104:107], v53 offset:25600
    v_mfma_f32_16x16x32_bf16 v[140:143], a[168:171], v[72:75], v[140:143]
    ds_read_b128 v[108:111], v53 offset:26624
    v_mfma_f32_16x16x32_bf16 v[144:147], a[172:175], v[72:75], v[144:147]
    ds_read_b128 v[112:115], v53 offset:27648
    v_mfma_f32_16x16x32_bf16 v[140:143], a[176:179], v[76:79], v[140:143]
    s_waitcnt vmcnt(9)
    s_mov_b64 exec, 1
    buffer_store_dword v61, off, s[24:27], s4 sc1
    s_mov_b64 exec, -1
    v_mfma_f32_16x16x32_bf16 v[144:147], a[180:183], v[76:79], v[144:147]
    v_mfma_f32_16x16x32_bf16 v[140:143], a[184:187], v[80:83], v[140:143]
    v_mfma_f32_16x16x32_bf16 v[144:147], a[188:191], v[80:83], v[144:147]
    s_barrier
    s_waitcnt lgkmcnt(4)
    v_mfma_f32_16x16x32_bf16 v[140:143], a[192:195], v[84:87], v[140:143]
    ds_read_b128 v[68:71], v53 offset:28672
    ds_read_b128 v[72:75], v53 offset:29696
    v_mfma_f32_16x16x32_bf16 v[144:147], a[196:199], v[84:87], v[144:147]
    ds_read_b128 v[76:79], v53 offset:30720
    v_mfma_f32_16x16x32_bf16 v[140:143], a[200:203], v[88:91], v[140:143]
    ds_read_b128 v[80:83], v53 offset:31744
    v_mfma_f32_16x16x32_bf16 v[144:147], a[204:207], v[88:91], v[144:147]
    s_waitcnt vmcnt(9)
    s_mov_b64 exec, 1
    buffer_store_dword v61, off, s[24:27], s5 sc1
    s_mov_b64 exec, -1
    v_mfma_f32_16x16x32_bf16 v[140:143], a[208:211], v[92:95], v[140:143]
    s_nop 2
    v_cvt_pk_bf16_f32 v244, v124, v125
    v_mfma_f32_16x16x32_bf16 v[144:147], a[212:215], v[92:95], v[144:147]
    v_cvt_pk_bf16_f32 v245, v126, v127
    v_mfma_f32_16x16x32_bf16 v[140:143], a[216:219], v[96:99], v[140:143]
    v_cvt_pk_bf16_f32 v246, v128, v129
    v_mfma_f32_16x16x32_bf16 v[144:147], a[220:223], v[96:99], v[144:147]
    v_cvt_pk_bf16_f32 v247, v130, v131
    s_waitcnt lgkmcnt(4)
    v_mfma_f32_16x16x32_bf16 v[140:143], a[224:227], v[100:103], v[140:143]
    ds_read_b128 v[84:87], v53 offset:32768
    ds_read_b128 v[88:91], v53 offset:33792
    v_mfma_f32_16x16x32_bf16 v[144:147], a[228:231], v[100:103], v[144:147]
    ds_read_b128 v[92:95], v53 offset:34816
    ds_read_b128 v[96:99], v53 offset:35840
    v_mfma_f32_16x16x32_bf16 v[140:143], a[232:235], v[104:107], v[140:143]
    s_waitcnt vmcnt(7)
    s_mov_b64 exec, 1
    buffer_store_dword v61, off, s[24:27], s0 sc1
    s_mov_b64 exec, -1
    v_mfma_f32_16x16x32_bf16 v[144:147], a[236:239], v[104:107], v[144:147]
    buffer_store_dwordx4 v[244:247], v53, s[24:27], s74 offen sc1
    v_mfma_f32_16x16x32_bf16 v[140:143], a[240:243], v[108:111], v[140:143]
    s_nop 2
    v_cvt_pk_bf16_f32 v248, v132, v133
    v_mfma_f32_16x16x32_bf16 v[144:147], a[244:247], v[108:111], v[144:147]
    v_cvt_pk_bf16_f32 v249, v134, v135
    v_mfma_f32_16x16x32_bf16 v[140:143], a[248:251], v[112:115], v[140:143]
    v_cvt_pk_bf16_f32 v250, v136, v137
    v_mfma_f32_16x16x32_bf16 v[144:147], a[252:255], v[112:115], v[144:147]
    v_cvt_pk_bf16_f32 v251, v138, v139
    s_waitcnt lgkmcnt(4)
    v_mfma_f32_16x16x32_bf16 v[148:151], a[32:35], v[68:71], v[148:151]
    ds_read_b128 v[100:103], v53 offset:36864
    ds_read_b128 v[104:107], v53 offset:37888
    v_mfma_f32_16x16x32_bf16 v[152:155], a[36:39], v[68:71], v[152:155]
    ds_read_b128 v[108:111], v53 offset:38912
    ds_read_b128 v[112:115], v53 offset:39936
    v_mfma_f32_16x16x32_bf16 v[148:151], a[40:43], v[72:75], v[148:151]
    buffer_store_dwordx4 v[248:251], v53, s[24:27], s75 offen sc1
    v_mfma_f32_16x16x32_bf16 v[152:155], a[44:47], v[72:75], v[152:155]
    s_nop 2
    v_cvt_pk_bf16_f32 v252, v140, v141
    v_mfma_f32_16x16x32_bf16 v[148:151], a[48:51], v[76:79], v[148:151]
    v_cvt_pk_bf16_f32 v253, v142, v143
    v_mfma_f32_16x16x32_bf16 v[152:155], a[52:55], v[76:79], v[152:155]
    v_cvt_pk_bf16_f32 v254, v144, v145
    v_mfma_f32_16x16x32_bf16 v[148:151], a[56:59], v[80:83], v[148:151]
    v_cvt_pk_bf16_f32 v255, v146, v147
    v_mfma_f32_16x16x32_bf16 v[152:155], a[60:63], v[80:83], v[152:155]
    buffer_store_dwordx4 v[252:255], v53, s[24:27], s76 offen sc1
    s_waitcnt lgkmcnt(4)
    v_mfma_f32_16x16x32_bf16 v[148:151], a[64:67], v[84:87], v[148:151]
    ds_read_b128 v[68:71], v53 offset:40960
    v_mfma_f32_16x16x32_bf16 v[152:155], a[68:71], v[84:87], v[152:155]
    ds_read_b128 v[72:75], v53 offset:41984
    v_mfma_f32_16x16x32_bf16 v[148:151], a[72:75], v[88:91], v[148:151]
    ds_read_b128 v[76:79], v53 offset:43008
    v_mfma_f32_16x16x32_bf16 v[152:155], a[76:79], v[88:91], v[152:155]
    ds_read_b128 v[80:83], v53 offset:44032
    v_mfma_f32_16x16x32_bf16 v[148:151], a[80:83], v[92:95], v[148:151]
    v_mfma_f32_16x16x32_bf16 v[152:155], a[84:87], v[92:95], v[152:155]
    v_mfma_f32_16x16x32_bf16 v[148:151], a[88:91], v[96:99], v[148:151]
    v_mfma_f32_16x16x32_bf16 v[152:155], a[92:95], v[96:99], v[152:155]
    s_waitcnt lgkmcnt(4)
    v_mfma_f32_16x16x32_bf16 v[148:151], a[96:99], v[100:103], v[148:151]
    ds_read_b128 v[84:87], v53 offset:45056
    v_mfma_f32_16x16x32_bf16 v[152:155], a[100:103], v[100:103], v[152:155]
    ds_read_b128 v[88:91], v53 offset:46080
    v_mfma_f32_16x16x32_bf16 v[148:151], a[104:107], v[104:107], v[148:151]
    ds_read_b128 v[92:95], v53 offset:47104
    v_mfma_f32_16x16x32_bf16 v[152:155], a[108:111], v[104:107], v[152:155]
    ds_read_b128 v[96:99], v53 offset:48128
    v_mfma_f32_16x16x32_bf16 v[148:151], a[112:115], v[108:111], v[148:151]
    v_mfma_f32_16x16x32_bf16 v[152:155], a[116:119], v[108:111], v[152:155]
    v_mfma_f32_16x16x32_bf16 v[148:151], a[120:123], v[112:115], v[148:151]
    v_mfma_f32_16x16x32_bf16 v[152:155], a[124:127], v[112:115], v[152:155]
    s_waitcnt lgkmcnt(4)
    v_mfma_f32_16x16x32_bf16 v[148:151], a[128:131], v[68:71], v[148:151]
    ds_read_b128 v[100:103], v53 offset:49152
    v_mfma_f32_16x16x32_bf16 v[152:155], a[132:135], v[68:71], v[152:155]
    ds_read_b128 v[104:107], v53 offset:50176
    v_mfma_f32_16x16x32_bf16 v[148:151], a[136:139], v[72:75], v[148:151]
    ds_read_b128 v[108:111], v53 offset:51200
    v_mfma_f32_16x16x32_bf16 v[152:155], a[140:143], v[72:75], v[152:155]
    ds_read_b128 v[112:115], v53 offset:52224
    v_mfma_f32_16x16x32_bf16 v[148:151], a[144:147], v[76:79], v[148:151]
    v_mfma_f32_16x16x32_bf16 v[152:155], a[148:151], v[76:79], v[152:155]
    v_mfma_f32_16x16x32_bf16 v[148:151], a[152:155], v[80:83], v[148:151]
    v_mfma_f32_16x16x32_bf16 v[152:155], a[156:159], v[80:83], v[152:155]
    s_waitcnt lgkmcnt(4)
    v_mfma_f32_16x16x32_bf16 v[148:151], a[160:163], v[84:87], v[148:151]
    ds_read_b128 v[68:71], v53 offset:53248
    v_mfma_f32_16x16x32_bf16 v[152:155], a[164:167], v[84:87], v[152:155]
    ds_read_b128 v[72:75], v53 offset:54272
    v_mfma_f32_16x16x32_bf16 v[148:151], a[168:171], v[88:91], v[148:151]
    ds_read_b128 v[76:79], v53 offset:55296
    v_mfma_f32_16x16x32_bf16 v[152:155], a[172:175], v[88:91], v[152:155]
    ds_read_b128 v[80:83], v53 offset:56320
    v_mfma_f32_16x16x32_bf16 v[148:151], a[176:179], v[92:95], v[148:151]
    v_mfma_f32_16x16x32_bf16 v[152:155], a[180:183], v[92:95], v[152:155]
    v_mfma_f32_16x16x32_bf16 v[148:151], a[184:187], v[96:99], v[148:151]
    v_mfma_f32_16x16x32_bf16 v[152:155], a[188:191], v[96:99], v[152:155]
    s_waitcnt vmcnt(6)
    s_barrier
    s_waitcnt lgkmcnt(4)
    v_mfma_f32_16x16x32_bf16 v[148:151], a[192:195], v[100:103], v[148:151]
    ds_read_b128 v[84:87], v53 offset:57344
    v_mfma_f32_16x16x32_bf16 v[152:155], a[196:199], v[100:103], v[152:155]
    ds_read_b128 v[88:91], v53 offset:58368
    v_mfma_f32_16x16x32_bf16 v[148:151], a[200:203], v[104:107], v[148:151]
    ds_read_b128 v[92:95], v53 offset:59392
    v_mfma_f32_16x16x32_bf16 v[152:155], a[204:207], v[104:107], v[152:155]
    ds_read_b128 v[96:99], v53 offset:60416
    v_mfma_f32_16x16x32_bf16 v[148:151], a[208:211], v[108:111], v[148:151]
    v_mfma_f32_16x16x32_bf16 v[152:155], a[212:215], v[108:111], v[152:155]
    v_mfma_f32_16x16x32_bf16 v[148:151], a[216:219], v[112:115], v[148:151]
    v_mfma_f32_16x16x32_bf16 v[152:155], a[220:223], v[112:115], v[152:155]
    s_waitcnt lgkmcnt(4)
    v_mfma_f32_16x16x32_bf16 v[148:151], a[224:227], v[68:71], v[148:151]
    ds_read_b128 v[100:103], v53 offset:61440
    v_mfma_f32_16x16x32_bf16 v[152:155], a[228:231], v[68:71], v[152:155]
    ds_read_b128 v[104:107], v53 offset:62464
    v_mfma_f32_16x16x32_bf16 v[148:151], a[232:235], v[72:75], v[148:151]
    ds_read_b128 v[108:111], v53 offset:63488
    v_mfma_f32_16x16x32_bf16 v[152:155], a[236:239], v[72:75], v[152:155]
    ds_read_b128 v[112:115], v53 offset:64512
    v_mfma_f32_16x16x32_bf16 v[148:151], a[240:243], v[76:79], v[148:151]
    buffer_load_dword v5, v58, s[24:27], 0 offen sc1
    v_mfma_f32_16x16x32_bf16 v[152:155], a[244:247], v[76:79], v[152:155]
    v_mfma_f32_16x16x32_bf16 v[148:151], a[248:251], v[80:83], v[148:151]
    v_mfma_f32_16x16x32_bf16 v[152:155], a[252:255], v[80:83], v[152:155]
    s_waitcnt lgkmcnt(4)
    v_mfma_f32_16x16x32_bf16 v[156:159], a[32:35], v[84:87], v[156:159]
    ds_read_b128 v[68:71], v64 offset:16384
    ds_read_b128 v[72:75], v64 offset:17408
    v_mfma_f32_16x16x32_bf16 v[160:163], a[36:39], v[84:87], v[160:163]
    ds_read_b128 v[76:79], v64 offset:18432
    v_mfma_f32_16x16x32_bf16 v[156:159], a[40:43], v[88:91], v[156:159]
    ds_read_b128 v[80:83], v64 offset:19456
    v_mfma_f32_16x16x32_bf16 v[160:163], a[44:47], v[88:91], v[160:163]
    s_nop 2
    v_cvt_pk_bf16_f32 v244, v148, v149
    v_mfma_f32_16x16x32_bf16 v[156:159], a[48:51], v[92:95], v[156:159]
    v_cvt_pk_bf16_f32 v245, v150, v151
    v_mfma_f32_16x16x32_bf16 v[160:163], a[52:55], v[92:95], v[160:163]
    v_cvt_pk_bf16_f32 v246, v152, v153
    v_mfma_f32_16x16x32_bf16 v[156:159], a[56:59], v[96:99], v[156:159]
    v_cvt_pk_bf16_f32 v247, v154, v155
    v_mfma_f32_16x16x32_bf16 v[160:163], a[60:63], v[96:99], v[160:163]
    buffer_store_dwordx4 v[244:247], v53, s[24:27], s77 offen sc1
    s_waitcnt lgkmcnt(4)
    v_mfma_f32_16x16x32_bf16 v[156:159], a[64:67], v[100:103], v[156:159]
    ds_read_b128 v[84:87], v64 offset:20480
    v_mfma_f32_16x16x32_bf16 v[160:163], a[68:71], v[100:103], v[160:163]
    ds_read_b128 v[88:91], v64 offset:21504
    v_mfma_f32_16x16x32_bf16 v[156:159], a[72:75], v[104:107], v[156:159]
    ds_read_b128 v[92:95], v64 offset:22528
    v_mfma_f32_16x16x32_bf16 v[160:163], a[76:79], v[104:107], v[160:163]
    ds_read_b128 v[96:99], v64 offset:23552
    v_mfma_f32_16x16x32_bf16 v[156:159], a[80:83], v[108:111], v[156:159]
    v_mfma_f32_16x16x32_bf16 v[160:163], a[84:87], v[108:111], v[160:163]
    v_mfma_f32_16x16x32_bf16 v[156:159], a[88:91], v[112:115], v[156:159]
    v_mfma_f32_16x16x32_bf16 v[160:163], a[92:95], v[112:115], v[160:163]
    s_waitcnt lgkmcnt(4)
    v_mfma_f32_16x16x32_bf16 v[156:159], a[96:99], v[68:71], v[156:159]
    ds_read_b128 v[100:103], v64 offset:24576
    v_mfma_f32_16x16x32_bf16 v[160:163], a[100:103], v[68:71], v[160:163]
    ds_read_b128 v[104:107], v64 offset:25600
    v_mfma_f32_16x16x32_bf16 v[156:159], a[104:107], v[72:75], v[156:159]
    ds_read_b128 v[108:111], v64 offset:26624
    v_mfma_f32_16x16x32_bf16 v[160:163], a[108:111], v[72:75], v[160:163]
    ds_read_b128 v[112:115], v64 offset:27648
    v_mfma_f32_16x16x32_bf16 v[156:159], a[112:115], v[76:79], v[156:159]
    v_mfma_f32_16x16x32_bf16 v[160:163], a[116:119], v[76:79], v[160:163]
    v_mfma_f32_16x16x32_bf16 v[156:159], a[120:123], v[80:83], v[156:159]
    v_mfma_f32_16x16x32_bf16 v[160:163], a[124:127], v[80:83], v[160:163]
    s_waitcnt lgkmcnt(4)
    v_mfma_f32_16x16x32_bf16 v[156:159], a[128:131], v[84:87], v[156:159]
    ds_read_b128 v[68:71], v64 offset:28672
    v_mfma_f32_16x16x32_bf16 v[160:163], a[132:135], v[84:87], v[160:163]
    ds_read_b128 v[72:75], v64 offset:29696
    v_mfma_f32_16x16x32_bf16 v[156:159], a[136:139], v[88:91], v[156:159]
    ds_read_b128 v[76:79], v64 offset:30720
    v_mfma_f32_16x16x32_bf16 v[160:163], a[140:143], v[88:91], v[160:163]
    ds_read_b128 v[80:83], v64 offset:31744
    v_mfma_f32_16x16x32_bf16 v[156:159], a[144:147], v[92:95], v[156:159]
    v_mfma_f32_16x16x32_bf16 v[160:163], a[148:151], v[92:95], v[160:163]
    v_mfma_f32_16x16x32_bf16 v[156:159], a[152:155], v[96:99], v[156:159]
    v_mfma_f32_16x16x32_bf16 v[160:163], a[156:159], v[96:99], v[160:163]
    s_waitcnt lgkmcnt(4)
    v_mfma_f32_16x16x32_bf16 v[156:159], a[160:163], v[100:103], v[156:159]
    ds_read_b128 v[84:87], v63 offset:49152
    v_mfma_f32_16x16x32_bf16 v[160:163], a[164:167], v[100:103], v[160:163]
    ds_read_b128 v[88:91], v63 offset:50176
    v_mfma_f32_16x16x32_bf16 v[156:159], a[168:171], v[104:107], v[156:159]
    ds_read_b128 v[92:95], v63 offset:51200
    v_mfma_f32_16x16x32_bf16 v[160:163], a[172:175], v[104:107], v[160:163]
    ds_read_b128 v[96:99], v63 offset:52224
    v_mfma_f32_16x16x32_bf16 v[156:159], a[176:179], v[108:111], v[156:159]
    v_mfma_f32_16x16x32_bf16 v[160:163], a[180:183], v[108:111], v[160:163]
    v_mfma_f32_16x16x32_bf16 v[156:159], a[184:187], v[112:115], v[156:159]
    v_mfma_f32_16x16x32_bf16 v[160:163], a[188:191], v[112:115], v[160:163]
    s_waitcnt lgkmcnt(4)
    v_mfma_f32_16x16x32_bf16 v[156:159], a[192:195], v[68:71], v[156:159]
    ds_read_b128 v[100:103], v63 offset:0
    v_mfma_f32_16x16x32_bf16 v[160:163], a[196:199], v[68:71], v[160:163]
    ds_read_b128 v[104:107], v63 offset:1024
    v_mfma_f32_16x16x32_bf16 v[156:159], a[200:203], v[72:75], v[156:159]
    ds_read_b128 v[108:111], v63 offset:2048
    v_mfma_f32_16x16x32_bf16 v[160:163], a[204:207], v[72:75], v[160:163]
    ds_read_b128 v[112:115], v63 offset:3072
    v_mfma_f32_16x16x32_bf16 v[156:159], a[208:211], v[76:79], v[156:159]
    v_mfma_f32_16x16x32_bf16 v[160:163], a[212:215], v[76:79], v[160:163]
    v_mfma_f32_16x16x32_bf16 v[156:159], a[216:219], v[80:83], v[156:159]
    v_mfma_f32_16x16x32_bf16 v[160:163], a[220:223], v[80:83], v[160:163]
    s_waitcnt lgkmcnt(4)
    v_mfma_f32_16x16x32_bf16 v[156:159], a[224:227], v[84:87], v[156:159]
    ds_read_b128 v[68:71], v63 offset:4096
    ds_read_b128 v[72:75], v63 offset:5120
    v_mfma_f32_16x16x32_bf16 v[160:163], a[228:231], v[84:87], v[160:163]
    ds_read_b128 v[76:79], v63 offset:6144
    ds_read_b128 v[80:83], v63 offset:7168
    v_mfma_f32_16x16x32_bf16 v[156:159], a[232:235], v[88:91], v[156:159]
    s_waitcnt vmcnt(1)
    v_cmp_ne_u32 vcc, 0, v5
    v_mfma_f32_16x16x32_bf16 v[160:163], a[236:239], v[88:91], v[160:163]
    s_nop 0
    v_mfma_f32_16x16x32_bf16 v[156:159], a[240:243], v[92:95], v[156:159]
    s_and_b32 s69, vcc_lo, s68
    s_cmp_eq_u32 s69, s68
    s_cselect_b32 s69, 1, 0
    v_mfma_f32_16x16x32_bf16 v[160:163], a[244:247], v[92:95], v[160:163]
    buffer_load_dwordx4 v[172:175], v53, s[24:27], s79 offen sc1
    v_mfma_f32_16x16x32_bf16 v[156:159], a[248:251], v[96:99], v[156:159]
    buffer_load_dwordx4 v[176:179], v53, s[24:27], s80 offen sc1
    v_mfma_f32_16x16x32_bf16 v[160:163], a[252:255], v[96:99], v[160:163]
    buffer_load_dwordx4 v[180:183], v53, s[24:27], s81 offen sc1
    s_waitcnt lgkmcnt(4)
    v_mfma_f32_16x16x32_bf16 v[164:167], a[32:35], v[100:103], v[164:167]
    ds_read_b128 v[84:87], v63 offset:8192
    ds_read_b128 v[88:91], v63 offset:9216
    v_mfma_f32_16x16x32_bf16 v[168:171], a[36:39], v[100:103], v[168:171]
    ds_read_b128 v[92:95], v63 offset:10240
    v_mfma_f32_16x16x32_bf16 v[164:167], a[40:43], v[104:107], v[164:167]
    ds_read_b128 v[96:99], v63 offset:11264
    v_mfma_f32_16x16x32_bf16 v[168:171], a[44:47], v[104:107], v[168:171]
    s_nop 2
    v_cvt_pk_bf16_f32 v248, v156, v157
    v_mfma_f32_16x16x32_bf16 v[164:167], a[48:51], v[108:111], v[164:167]
    v_cvt_pk_bf16_f32 v249, v158, v159
    v_mfma_f32_16x16x32_bf16 v[168:171], a[52:55], v[108:111], v[168:171]
    v_cvt_pk_bf16_f32 v250, v160, v161
    v_mfma_f32_16x16x32_bf16 v[164:167], a[56:59], v[112:115], v[164:167]
    v_cvt_pk_bf16_f32 v251, v162, v163
    v_mfma_f32_16x16x32_bf16 v[168:171], a[60:63], v[112:115], v[168:171]
    s_andn2_b64 exec, exec, s[6:7]
    buffer_store_dwordx4 v[248:251], v53, s[24:27], s78 offen sc1
    s_mov_b64 exec, -1
    s_waitcnt lgkmcnt(4)
    v_mfma_f32_16x16x32_bf16 v[164:167], a[64:67], v[68:71], v[164:167]
    ds_read_b128 v[100:103], v63 offset:12288
    v_mfma_f32_16x16x32_bf16 v[168:171], a[68:71], v[68:71], v[168:171]
    ds_read_b128 v[104:107], v63 offset:13312
    v_mfma_f32_16x16x32_bf16 v[164:167], a[72:75], v[72:75], v[164:167]
    ds_read_b128 v[108:111], v63 offset:14336
    v_mfma_f32_16x16x32_bf16 v[168:171], a[76:79], v[72:75], v[168:171]
    ds_read_b128 v[112:115], v63 offset:15360
    v_mfma_f32_16x16x32_bf16 v[164:167], a[80:83], v[76:79], v[164:167]
    buffer_load_dword v2, v58, s[24:27], 0 offen sc1
    v_mfma_f32_16x16x32_bf16 v[168:171], a[84:87], v[76:79], v[168:171]
    v_mfma_f32_16x16x32_bf16 v[164:167], a[88:91], v[80:83], v[164:167]
    v_mfma_f32_16x16x32_bf16 v[168:171], a[92:95], v[80:83], v[168:171]
    s_waitcnt lgkmcnt(4)
    v_mfma_f32_16x16x32_bf16 v[164:167], a[96:99], v[84:87], v[164:167]
    ds_read_b128 v[68:71], v63 offset:16384
    v_mfma_f32_16x16x32_bf16 v[168:171], a[100:103], v[84:87], v[168:171]
    ds_read_b128 v[72:75], v63 offset:17408
    v_mfma_f32_16x16x32_bf16 v[164:167], a[104:107], v[88:91], v[164:167]
    ds_read_b128 v[76:79], v63 offset:18432
    v_mfma_f32_16x16x32_bf16 v[168:171], a[108:111], v[88:91], v[168:171]
    ds_read_b128 v[80:83], v63 offset:19456
    v_mfma_f32_16x16x32_bf16 v[164:167], a[112:115], v[92:95], v[164:167]
    v_mfma_f32_16x16x32_bf16 v[168:171], a[116:119], v[92:95], v[168:171]
    v_mfma_f32_16x16x32_bf16 v[164:167], a[120:123], v[96:99], v[164:167]
    v_mfma_f32_16x16x32_bf16 v[168:171], a[124:127], v[96:99], v[168:171]
    s_waitcnt lgkmcnt(4)
    v_mfma_f32_16x16x32_bf16 v[164:167], a[128:131], v[100:103], v[164:167]
    ds_read_b128 v[84:87], v63 offset:20480
    v_mfma_f32_16x16x32_bf16 v[168:171], a[132:135], v[100:103], v[168:171]
    ds_read_b128 v[88:91], v63 offset:21504
    v_mfma_f32_16x16x32_bf16 v[164:167], a[136:139], v[104:107], v[164:167]
    ds_read_b128 v[92:95], v63 offset:22528
    v_mfma_f32_16x16x32_bf16 v[168:171], a[140:143], v[104:107], v[168:171]
    ds_read_b128 v[96:99], v63 offset:23552
    v_mfma_f32_16x16x32_bf16 v[164:167], a[144:147], v[108:111], v[164:167]
    s_mov_b64 exec, s[6:7]
    buffer_load_dwordx4 v[196:199], v53, s[24:27], s82 offen offset:0 sc1
    buffer_load_dwordx4 v[200:203], v53, s[24:27], s83 offen offset:0 sc1
    buffer_load_dwordx4 v[204:207], v53, s[24:27], s89 offen offset:0 sc1
    s_mov_b64 exec, -1
    v_mfma_f32_16x16x32_bf16 v[168:171], a[148:151], v[108:111], v[168:171]
    v_mfma_f32_16x16x32_bf16 v[164:167], a[152:155], v[112:115], v[164:167]
    v_mfma_f32_16x16x32_bf16 v[168:171], a[156:159], v[112:115], v[168:171]
    s_waitcnt lgkmcnt(4)
    v_mfma_f32_16x16x32_bf16 v[164:167], a[160:163], v[68:71], v[164:167]
    ds_read_b128 v[100:103], v63 offset:24576
    v_mfma_f32_16x16x32_bf16 v[168:171], a[164:167], v[68:71], v[168:171]
    ds_read_b128 v[104:107], v63 offset:25600
    v_mfma_f32_16x16x32_bf16 v[164:167], a[168:171], v[72:75], v[164:167]
    ds_read_b128 v[108:111], v63 offset:26624
    v_mfma_f32_16x16x32_bf16 v[168:171], a[172:175], v[72:75], v[168:171]
    ds_read_b128 v[112:115], v63 offset:27648
    v_mfma_f32_16x16x32_bf16 v[164:167], a[176:179], v[76:79], v[164:167]
    v_mfma_f32_16x16x32_bf16 v[168:171], a[180:183], v[76:79], v[168:171]
    v_mfma_f32_16x16x32_bf16 v[164:167], a[184:187], v[80:83], v[164:167]
    v_mfma_f32_16x16x32_bf16 v[168:171], a[188:191], v[80:83], v[168:171]
    s_waitcnt lgkmcnt(4)
    v_mfma_f32_16x16x32_bf16 v[164:167], a[192:195], v[84:87], v[164:167]
    v_mfma_f32_16x16x32_bf16 v[168:171], a[196:199], v[84:87], v[168:171]
    v_mfma_f32_16x16x32_bf16 v[164:167], a[200:203], v[88:91], v[164:167]
    v_mfma_f32_16x16x32_bf16 v[168:171], a[204:207], v[88:91], v[168:171]
    v_mfma_f32_16x16x32_bf16 v[164:167], a[208:211], v[92:95], v[164:167]
    v_mfma_f32_16x16x32_bf16 v[168:171], a[212:215], v[92:95], v[168:171]
    v_mfma_f32_16x16x32_bf16 v[164:167], a[216:219], v[96:99], v[164:167]
    v_mfma_f32_16x16x32_bf16 v[168:171], a[220:223], v[96:99], v[168:171]
    s_waitcnt lgkmcnt(0)
    v_mfma_f32_16x16x32_bf16 v[164:167], a[224:227], v[100:103], v[164:167]
    v_mfma_f32_16x16x32_bf16 v[168:171], a[228:231], v[100:103], v[168:171]
    v_mfma_f32_16x16x32_bf16 v[164:167], a[232:235], v[104:107], v[164:167]
    v_mfma_f32_16x16x32_bf16 v[168:171], a[236:239], v[104:107], v[168:171]
    v_mfma_f32_16x16x32_bf16 v[164:167], a[240:243], v[108:111], v[164:167]
    v_mfma_f32_16x16x32_bf16 v[168:171], a[244:247], v[108:111], v[168:171]
    v_mfma_f32_16x16x32_bf16 v[164:167], a[248:251], v[112:115], v[164:167]
    v_mfma_f32_16x16x32_bf16 v[168:171], a[252:255], v[112:115], v[168:171]
    s_mov_b32 s88, 0
    s_cmp_eq_u32 s69, 1
    s_cbranch_scc1 L_f2_fast
    s_waitcnt vmcnt(3)
L_f2_chk:
    v_cmp_ne_u32 vcc, 0, v2
    s_add_u32 s88, s88, 1
    s_and_b32 s56, vcc_lo, s68
    s_cmp_eq_u32 s56, s68
    s_cbranch_scc1 L_f2_ok
    s_cmp_ge_u32 s88, 200000
    s_cbranch_scc1 L_f2_ok
    buffer_load_dword v2, v58, s[24:27], 0 offen sc1
    s_waitcnt vmcnt(0)
    s_branch L_f2_chk
L_f2_ok:
    buffer_load_dwordx4 v[172:175], v53, s[24:27], s79 offen sc1
    buffer_load_dwordx4 v[176:179], v53, s[24:27], s80 offen sc1
    buffer_load_dwordx4 v[180:183], v53, s[24:27], s81 offen sc1
    s_mov_b64 exec, s[6:7]
    buffer_load_dwordx4 v[196:199], v53, s[24:27], s82 offen offset:0 sc1
    buffer_load_dwordx4 v[200:203], v53, s[24:27], s83 offen offset:0 sc1
    buffer_load_dwordx4 v[204:207], v53, s[24:27], s89 offen offset:0 sc1
    s_mov_b64 exec, -1
    s_waitcnt vmcnt(0)
    s_mov_b32 s88, 0
L_f2_fast:
    s_cmp_eq_u32 s84, 1
    s_cbranch_scc0 L_fin_one
    buffer_load_dwordx4 v[208:211], v53, s[24:27], s82 offen sc1
    buffer_load_dwordx4 v[212:215], v53, s[24:27], s83 offen sc1
    buffer_load_dwordx4 v[216:219], v53, s[24:27], s89 offen sc1
    s_waitcnt vmcnt(8)
L_fgc0:
    v_max3_u32 v4, v172, v173, v174
    v_max3_u32 v5, v175, v176, v177
    v_max3_u32 v4, v4, v178, v179
    v_max3_u32 v5, v5, v180, v181
    v_max3_u32 v4, v4, v182, v183
    v_max_u32 v4, v4, v5
    v_cmp_eq_u32 vcc, -1, v4
    s_nop 0
    s_add_u32 s88, s88, 1
    s_cbranch_vccz L_fgo0
    s_cmp_ge_u32 s88, 200000
    s_cbranch_scc1 L_fgo0
    buffer_load_dwordx4 v[172:175], v53, s[24:27], s79 offen sc1
    buffer_load_dwordx4 v[176:179], v53, s[24:27], s80 offen sc1
    buffer_load_dwordx4 v[180:183], v53, s[24:27], s81 offen sc1
    s_waitcnt vmcnt(0)
    s_branch L_fgc0
L_fgo0:
    v_lshlrev_b32 v228, 16, v172
    v_and_b32 v229, 0xffff0000, v172
    v_lshlrev_b32 v230, 16, v173
    v_and_b32 v231, 0xffff0000, v173
    v_lshlrev_b32 v232, 16, v174
    v_and_b32 v233, 0xffff0000, v174
    v_lshlrev_b32 v234, 16, v175
    v_and_b32 v235, 0xffff0000, v175
    v_pk_add_f32 v[164:165], v[164:165], v[228:229]
    v_pk_add_f32 v[166:167], v[166:167], v[230:231]
    v_pk_add_f32 v[168:169], v[168:169], v[232:233]
    v_pk_add_f32 v[170:171], v[170:171], v[234:235]
    v_lshlrev_b32 v228, 16, v176
    v_and_b32 v229, 0xffff0000, v176
    v_lshlrev_b32 v230, 16, v177
    v_and_b32 v231, 0xffff0000, v177
    v_lshlrev_b32 v232, 16, v178
    v_and_b32 v233, 0xffff0000, v178
    v_lshlrev_b32 v234, 16, v179
    v_and_b32 v235, 0xffff0000, v179
    v_pk_add_f32 v[164:165], v[164:165], v[228:229]
    v_pk_add_f32 v[166:167], v[166:167], v[230:231]
    v_pk_add_f32 v[168:169], v[168:169], v[232:233]
    v_pk_add_f32 v[170:171], v[170:171], v[234:235]
    v_lshlrev_b32 v228, 16, v180
    v_and_b32 v229, 0xffff0000, v180
    v_lshlrev_b32 v230, 16, v181
    v_and_b32 v231, 0xffff0000, v181
    v_lshlrev_b32 v232, 16, v182
    v_and_b32 v233, 0xffff0000, v182
    v_lshlrev_b32 v234, 16, v183
    v_and_b32 v235, 0xffff0000, v183
    v_pk_add_f32 v[164:165], v[164:165], v[228:229]
    v_pk_add_f32 v[166:167], v[166:167], v[230:231]
    v_pk_add_f32 v[168:169], v[168:169], v[232:233]
    v_pk_add_f32 v[170:171], v[170:171], v[234:235]
    v_cvt_pk_bf16_f32 v220, v164, v165
    v_cvt_pk_bf16_f32 v221, v166, v167
    v_cvt_pk_bf16_f32 v222, v168, v169
    v_cvt_pk_bf16_f32 v223, v170, v171
    s_waitcnt vmcnt(3)
    v_max3_u32 v4, v196, v197, v198
    v_max3_u32 v5, v199, v200, v201
    v_max3_u32 v4, v4, v202, v203
    v_max3_u32 v5, v5, v204, v205
    v_max3_u32 v4, v4, v206, v207
    v_max_u32 v4, v4, v5
    v_cmp_eq_u32 vcc, -1, v4
    s_nop 0
    s_cbranch_vccz L_hgA_ok
    buffer_load_dwordx4 v[196:199], v53, s[24:27], s82 offen sc1
    buffer_load_dwordx4 v[200:203], v53, s[24:27], s83 offen sc1
    buffer_load_dwordx4 v[204:207], v53, s[24:27], s89 offen sc1
    s_waitcnt vmcnt(3)
    v_max3_u32 v4, v208, v209, v210
    v_max3_u32 v5, v211, v212, v213
    v_max3_u32 v4, v4, v214, v215
    v_max3_u32 v5, v5, v216, v217
    v_max3_u32 v4, v4, v218, v219
    v_max_u32 v4, v4, v5
    v_cmp_eq_u32 vcc, -1, v4
    s_nop 0
    s_cbranch_vccz L_hgB_ok
L_hg_loop:
    s_add_u32 s88, s88, 1
    s_cmp_ge_u32 s88, 200000
    s_cbranch_scc1 L_hgB_ok
    buffer_load_dwordx4 v[208:211], v53, s[24:27], s82 offen sc1
    buffer_load_dwordx4 v[212:215], v53, s[24:27], s83 offen sc1
    buffer_load_dwordx4 v[216:219], v53, s[24:27], s89 offen sc1
    s_waitcnt vmcnt(3)
    v_max3_u32 v4, v196, v197, v198
    v_max3_u32 v5, v199, v200, v201
    v_max3_u32 v4, v4, v202, v203
    v_max3_u32 v5, v5, v204, v205
    v_max3_u32 v4, v4, v206, v207
    v_max_u32 v4, v4, v5
    v_cmp_eq_u32 vcc, -1, v4
    s_nop 0
    s_cbranch_vccz L_hgA_ok
    buffer_load_dwordx4 v[196:199], v53, s[24:27], s82 offen sc1
    buffer_load_dwordx4 v[200:203], v53, s[24:27], s83 offen sc1
    buffer_load_dwordx4 v[204:207], v53, s[24:27], s89 offen sc1
    s_waitcnt vmcnt(3)
    v_max3_u32 v4, v208, v209, v210
    v_max3_u32 v5, v211, v212, v213
    v_max3_u32 v4, v4, v214, v215
    v_max3_u32 v5, v5, v216, v217
    v_max3_u32 v4, v4, v218, v219
    v_max_u32 v4, v4, v5
    v_cmp_eq_u32 vcc, -1, v4
    s_nop 0
    s_cbranch_vccnz L_hg_loop
L_hgB_ok:
    v_lshlrev_b32 v228, 16, v208
    v_and_b32 v229, 0xffff0000, v208
    v_lshlrev_b32 v230, 16, v209
    v_and_b32 v231, 0xffff0000, v209
    v_lshlrev_b32 v232, 16, v210
    v_and_b32 v233, 0xffff0000, v210
    v_lshlrev_b32 v234, 16, v211
    v_and_b32 v235, 0xffff0000, v211
    v_pk_add_f32 v[156:157], v[156:157], v[228:229]
    v_pk_add_f32 v[158:159], v[158:159], v[230:231]
    v_pk_add_f32 v[160:161], v[160:161], v[232:233]
    v_pk_add_f32 v[162:163], v[162:163], v[234:235]
    v_lshlrev_b32 v228, 16, v212
    v_and_b32 v229, 0xffff0000, v212
    v_lshlrev_b32 v230, 16, v213
    v_and_b32 v231, 0xffff0000, v213
    v_lshlrev_b32 v232, 16, v214
    v_and_b32 v233, 0xffff0000, v214
    v_lshlrev_b32 v234, 16, v215
    v_and_b32 v235, 0xffff0000, v215
    v_pk_add_f32 v[156:157], v[156:157], v[228:229]
    v_pk_add_f32 v[158:159], v[158:159], v[230:231]
    v_pk_add_f32 v[160:161], v[160:161], v[232:233]
    v_pk_add_f32 v[162:163], v[162:163], v[234:235]
    v_lshlrev_b32 v228, 16, v216
    v_and_b32 v229, 0xffff0000, v216
    v_lshlrev_b32 v230, 16, v217
    v_and_b32 v231, 0xffff0000, v217
    v_lshlrev_b32 v232, 16, v218
    v_and_b32 v233, 0xffff0000, v218
    v_lshlrev_b32 v234, 16, v219
    v_and_b32 v235, 0xffff0000, v219
    v_pk_add_f32 v[156:157], v[156:157], v[228:229]
    v_pk_add_f32 v[158:159], v[158:159], v[230:231]
    v_pk_add_f32 v[160:161], v[160:161], v[232:233]
    v_pk_add_f32 v[162:163], v[162:163], v[234:235]
    v_cvt_pk_bf16_f32 v224, v156, v157
    v_cvt_pk_bf16_f32 v225, v158, v159
    v_cvt_pk_bf16_f32 v226, v160, v161
    v_cvt_pk_bf16_f32 v227, v162, v163
    buffer_store_dwordx4 v[224:227], v3, s[32:35], s61 offen sc1
    buffer_store_dwordx4 v[220:223], v3, s[32:35], s60 offen sc1
    s_branch L_fin_done
L_hgA_ok:
    v_lshlrev_b32 v228, 16, v196
    v_and_b32 v229, 0xffff0000, v196
    v_lshlrev_b32 v230, 16, v197
    v_and_b32 v231, 0xffff0000, v197
    v_lshlrev_b32 v232, 16, v198
    v_and_b32 v233, 0xffff0000, v198
    v_lshlrev_b32 v234, 16, v199
    v_and_b32 v235, 0xffff0000, v199
    v_pk_add_f32 v[156:157], v[156:157], v[228:229]
    v_pk_add_f32 v[158:159], v[158:159], v[230:231]
    v_pk_add_f32 v[160:161], v[160:161], v[232:233]
    v_pk_add_f32 v[162:163], v[162:163], v[234:235]
    v_lshlrev_b32 v228, 16, v200
    v_and_b32 v229, 0xffff0000, v200
    v_lshlrev_b32 v230, 16, v201
    v_and_b32 v231, 0xffff0000, v201
    v_lshlrev_b32 v232, 16, v202
    v_and_b32 v233, 0xffff0000, v202
    v_lshlrev_b32 v234, 16, v203
    v_and_b32 v235, 0xffff0000, v203
    v_pk_add_f32 v[156:157], v[156:157], v[228:229]
    v_pk_add_f32 v[158:159], v[158:159], v[230:231]
    v_pk_add_f32 v[160:161], v[160:161], v[232:233]
    v_pk_add_f32 v[162:163], v[162:163], v[234:235]
    v_lshlrev_b32 v228, 16, v204
    v_and_b32 v229, 0xffff0000, v204
    v_lshlrev_b32 v230, 16, v205
    v_and_b32 v231, 0xffff0000, v205
    v_lshlrev_b32 v232, 16, v206
    v_and_b32 v233, 0xffff0000, v206
    v_lshlrev_b32 v234, 16, v207
    v_and_b32 v235, 0xffff0000, v207
    v_pk_add_f32 v[156:157], v[156:157], v[228:229]
    v_pk_add_f32 v[158:159], v[158:159], v[230:231]
    v_pk_add_f32 v[160:161], v[160:161], v[232:233]
    v_pk_add_f32 v[162:163], v[162:163], v[234:235]
    v_cvt_pk_bf16_f32 v224, v156, v157
    v_cvt_pk_bf16_f32 v225, v158, v159
    v_cvt_pk_bf16_f32 v226, v160, v161
    v_cvt_pk_bf16_f32 v227, v162, v163
    buffer_store_dwordx4 v[224:227], v3, s[32:35], s61 offen sc1
    buffer_store_dwordx4 v[220:223], v3, s[32:35], s60 offen sc1
    s_branch L_fin_done
L_fin_one:
    s_waitcnt vmcnt(0)
L_fgc1:
    v_max3_u32 v4, v172, v173, v174
    v_max3_u32 v5, v175, v176, v177
    v_max3_u32 v4, v4, v178, v179
    v_max3_u32 v5, v5, v180, v181
    v_max3_u32 v4, v4, v182, v183
    v_max_u32 v4, v4, v5
    v_cmp_eq_u32 vcc, -1, v4
    s_nop 0
    s_add_u32 s88, s88, 1
    s_cbranch_vccz L_fgo1
    s_cmp_ge_u32 s88, 200000
    s_cbranch_scc1 L_fgo1
    buffer_load_dwordx4 v[172:175], v53, s[24:27], s79 offen sc1
    buffer_load_dwordx4 v[176:179], v53, s[24:27], s80 offen sc1
    buffer_load_dwordx4 v[180:183], v53, s[24:27], s81 offen sc1
    s_waitcnt vmcnt(0)
    s_branch L_fgc1
L_fgo1:
    v_lshlrev_b32 v228, 16, v172
    v_and_b32 v229, 0xffff0000, v172
    v_lshlrev_b32 v230, 16, v173
    v_and_b32 v231, 0xffff0000, v173
    v_lshlrev_b32 v232, 16, v174
    v_and_b32 v233, 0xffff0000, v174
    v_lshlrev_b32 v234, 16, v175
    v_and_b32 v235, 0xffff0000, v175
    v_pk_add_f32 v[164:165], v[164:165], v[228:229]
    v_pk_add_f32 v[166:167], v[166:167], v[230:231]
    v_pk_add_f32 v[168:169], v[168:169], v[232:233]
    v_pk_add_f32 v[170:171], v[170:171], v[234:235]
    v_lshlrev_b32 v228, 16, v176
    v_and_b32 v229, 0xffff0000, v176
    v_lshlrev_b32 v230, 16, v177
    v_and_b32 v231, 0xffff0000, v177
    v_lshlrev_b32 v232, 16, v178
    v_and_b32 v233, 0xffff0000, v178
    v_lshlrev_b32 v234, 16, v179
    v_and_b32 v235, 0xffff0000, v179
    v_pk_add_f32 v[164:165], v[164:165], v[228:229]
    v_pk_add_f32 v[166:167], v[166:167], v[230:231]
    v_pk_add_f32 v[168:169], v[168:169], v[232:233]
    v_pk_add_f32 v[170:171], v[170:171], v[234:235]
    v_lshlrev_b32 v228, 16, v180
    v_and_b32 v229, 0xffff0000, v180
    v_lshlrev_b32 v230, 16, v181
    v_and_b32 v231, 0xffff0000, v181
    v_lshlrev_b32 v232, 16, v182
    v_and_b32 v233, 0xffff0000, v182
    v_lshlrev_b32 v234, 16, v183
    v_and_b32 v235, 0xffff0000, v183
    v_pk_add_f32 v[164:165], v[164:165], v[228:229]
    v_pk_add_f32 v[166:167], v[166:167], v[230:231]
    v_pk_add_f32 v[168:169], v[168:169], v[232:233]
    v_pk_add_f32 v[170:171], v[170:171], v[234:235]
    v_cvt_pk_bf16_f32 v220, v164, v165
    v_cvt_pk_bf16_f32 v221, v166, v167
    v_cvt_pk_bf16_f32 v222, v168, v169
    v_cvt_pk_bf16_f32 v223, v170, v171
    buffer_store_dwordx4 v[220:223], v3, s[32:35], s60 offen sc1
L_fin_done:
L_done:
    s_endpgm
.section .rodata,"a"
.p2align 6
.amdhsa_kernel standalone__mha_block_cached__near_ridge_kernel
  .amdhsa_next_free_vgpr 512
  .amdhsa_next_free_sgpr 102
  .amdhsa_accum_offset 256
  .amdhsa_group_segment_fixed_size 0
  .amdhsa_kernarg_size 64
  .amdhsa_user_sgpr_count 2
  .amdhsa_user_sgpr_kernarg_segment_ptr 1
  .amdhsa_system_sgpr_workgroup_id_x 1
.end_amdhsa_kernel
```
